```python
import torch

def _softmax(x, axis=-1):
    return torch.softmax(x, dim=axis)
def _gelu(x):
    return torch.nn.functional.gelu(x, approximate="tanh")
def _silu(x):
    return torch.nn.functional.silu(x)
def _sigmoid(x):
    return torch.sigmoid(x)
def _layernorm(x, axis=-1, eps=1e-5):
    m = x.mean(dim=axis, keepdim=True)
    v = x.var(dim=axis, keepdim=True, unbiased=False)
    return (x - m) / torch.sqrt(v + eps)
def _scatter_add(tgt, idx, src, axis=0):
    return tgt.clone().index_add_(axis, idx, src)
def _segment_sum(src, seg, n):
    out = torch.zeros((n,) + src.shape[1:], dtype=src.dtype)
    return out.index_add_(0, seg, src)
def _pad(x, pw):
    flat = tuple(v for pair in reversed(pw) for v in pair)
    return torch.nn.functional.pad(x, flat)

kernel_name = 'standalone__paged_block_table_kv_pagedattention__sampling'

def setup_inputs():

    _w = (lambda a: (lambda t: t.to(torch.bfloat16) if t.is_floating_point() else t)(torch.as_tensor(a)))
    B, Hq, Hkv, Sq, Skv, D = 8, 32, 8, 8, 2048, 128
    bs = 16
    nbps = max(1, Skv // bs)
    num_phys = B * nbps + 4
    bt = torch.randperm(num_phys)[: B * nbps].reshape(B, nbps).to(torch.int64)
    cl = (nbps * bs - (torch.arange(1, B + 1, dtype=torch.int64) * 2654435761) % max(1, nbps * bs // 2)).to(torch.int64)
    return {
        "q": _w((lambda *s: torch.randn(*s, dtype=torch.bfloat16) * 0.8)(B, Hq, Sq, D)),
        "k_cache": _w((lambda *s: torch.randn(*s, dtype=torch.bfloat16) * 0.8)(num_phys, bs, Hkv, D)),
        "v_cache": _w((lambda *s: torch.randn(*s, dtype=torch.bfloat16) * 0.05)(num_phys, bs, Hkv, D)),
        "block_table": _w(bt),
        "context_lens": _w(cl),
    }

def reference(q, k_cache, v_cache, block_table, context_lens):
    B, Hq, Sq, D = q.shape
    bs = k_cache.shape[1]
    Hkv = k_cache.shape[2]
    nbps = block_table.shape[1]
    Skv = nbps * bs
    bt = block_table.reshape(-1)
    k = (lambda x, *d: x.permute(*d))(k_cache[bt].reshape(B, Skv, Hkv, D), 0, 2, 1, 3)
    v = (lambda x, *d: x.permute(*d))(v_cache[bt].reshape(B, Skv, Hkv, D), 0, 2, 1, 3)
    g = Hq // Hkv
    qg = q.reshape(B, Hkv, g, Sq, D)
    scores = torch.einsum("bhgqd,bhkd->bhgqk", qg, k) * (D ** -0.5)
    pos = torch.arange(Skv)
    msk = pos[None, :] < context_lens[:, None]
    scores = torch.where(msk[:, None, None, None, :], scores, -1e9)
    p = _softmax(scores, axis=-1)
    out = torch.einsum("bhgqk,bhkd->bhgqd", p, v)
    return out.reshape(B, Hq, Sq, D)
```

```asm
; @launch grid=(256,1,1) block=(512,1,1) lds=163840
.amdgcn_target "amdgcn-amd-amdhsa--gfx950"
.text
.globl standalone__paged_block_table_kv_pagedattention__sampling_kernel
.p2align 8
.type standalone__paged_block_table_kv_pagedattention__sampling_kernel,@function
standalone__paged_block_table_kv_pagedattention__sampling_kernel:
  s_cmp_ge_u32 s2, 256
  s_cbranch_scc1 L_end
  s_load_dwordx8 s[4:11], s[0:1], 0
  s_load_dwordx4 s[12:15], s[0:1], 32
  s_load_dwordx2 s[16:17], s[0:1], 56
  v_lshrrev_b32 v28, 6, v0
  v_and_b32 v0, 63, v0
  s_and_b32 s19, s2, 7
  v_readfirstlane_b32 s18, v28
  s_lshr_b32 s20, s2, 3
  s_mov_b32 s69, s19
  s_and_b32 s70, s20, 15
  s_lshl_b32 s70, s70, 2
  s_bitcmp1_b32 0x4b, s69
  s_mov_b32 s72, 0x33322222
  s_mov_b32 s73, 0x66655553
  s_cmov_b32 s72, 0x41110000
  s_cmov_b32 s73, 0x77774444
  s_lshr_b64 s[74:75], s[72:73], s70
  s_and_b32 s21, s74, 15
  s_bitcmp1_b32 0x4b, s69
  s_mov_b32 s72, 0x21043210
  s_mov_b32 s73, 0x21032103
  s_cmov_b32 s72, 0x02103210
  s_cmov_b32 s73, 0x32104321
  s_lshr_b64 s[74:75], s[72:73], s70
  s_and_b32 s22, s74, 15
  s_bitcmp1_b32 0x4b, s69
  s_mov_b32 s72, 0x44455555
  s_mov_b32 s73, 0x33344444
  s_cmov_b32 s72, 0x53334444
  s_cmov_b32 s73, 0x44445555
  s_lshr_b64 s[74:75], s[72:73], s70
  s_and_b32 s23, s74, 15
  s_cmp_ge_u32 s20, 16
  s_mov_b32 s72, 0x03434101
  s_cmov_b32 s72, 0x27676525
  s_lshl_b32 s73, s69, 2
  s_lshr_b32 s19, s72, s73
  s_and_b32 s19, s19, 7
  s_sub_u32 s54, s20, s22
  s_mul_i32 s68, s23, s18
  s_add_u32 s68, s68, s22
  s_lshl_b32 s74, s21, 9
  s_lshl_b32 s75, s23, 3
  s_mov_b32 s76, s68
  s_min_u32 s70, s76, 127
  s_lshl_b32 s70, s70, 2
  s_add_u32 s70, s70, s74
  s_add_u32 s76, s76, s75
  s_min_u32 s71, s76, 127
  s_lshl_b32 s71, s71, 2
  s_add_u32 s71, s71, s74
  s_add_u32 s76, s76, s75
  s_min_u32 s72, s76, 127
  s_lshl_b32 s72, s72, 2
  s_add_u32 s72, s72, s74
  s_add_u32 s76, s76, s75
  s_min_u32 s73, s76, 127
  s_lshl_b32 s73, s73, 2
  s_add_u32 s73, s73, s74
  s_lshl_b32 s74, s21, 2
  s_lshl_b32 s75, s19, 5
  s_add_u32 s75, s75, s74
  s_lshl_b32 s59, s19, 8
  s_lshl_b32 s101, s18, 12
  v_mov_b32 v28, s75
  v_and_b32 v1, 15, v0
  v_lshrrev_b32 v2, 4, v0
  v_lshlrev_b32 v27, 4, v0
  s_waitcnt lgkmcnt(0)
  s_load_dwordx8 s[36:43], s[12:13], 0
  s_load_dword s49, s[12:13], s74
  s_load_dword s55, s[10:11], s70
  s_load_dword s56, s[10:11], s71
  s_load_dword s57, s[10:11], s72
  s_load_dword s58, s[10:11], s73
  s_mov_b32 s44, s16
  s_and_b32 s45, s17, 0xffff
  s_mov_b32 s46, 16777216
  s_mov_b32 s47, 0x20000
  s_mul_i32 s60, s2, 32768
  s_mul_i32 s61, s18, 2048
  s_add_u32 s60, s60, s61
  s_add_u32 s60, s60, 1048576
  s_mul_i32 s61, s18, s23
  s_lshr_b32 s62, s61, 4
  s_cmp_eq_u32 s62, s22
  s_cbranch_scc1 L_pf_1
  buffer_load_dwordx4 v[76:79], v27, s[44:47], s60 offen sc1
L_pf_1:
  s_lshl_b32 s62, s23, 3
  s_add_u32 s61, s61, s62
  s_add_u32 s60, s60, 16384
  s_lshr_b32 s62, s61, 4
  s_cmp_eq_u32 s62, s22
  s_cbranch_scc1 L_pf_2
  buffer_load_dwordx4 v[76:79], v27, s[44:47], s60 offen sc1
L_pf_2:
  s_cmp_gt_u32 s18, 1
  s_cbranch_scc1 L_pf_3
  s_lshl_b32 s60, s2, 9
  s_lshl_b32 s61, s18, 8
  s_add_u32 s60, s60, s61
  s_add_u32 s60, s60, 8192
  s_mov_b64 exec, 0xffff
  buffer_load_dwordx4 v[76:79], v27, s[44:47], s60 offen sc1
  s_mov_b64 exec, -1
L_pf_3:
  global_load_dword v3, v28, s[16:17] sc1
  s_mov_b32 s24, s6
  s_and_b32 s25, s7, 0xffff
  s_mov_b32 s26, 33685504
  s_mov_b32 s27, 0x20000
  s_mov_b32 s28, s8
  s_and_b32 s29, s9, 0xffff
  s_mov_b32 s30, 33685504
  s_mov_b32 s31, 0x20000
  s_mov_b32 s32, s4
  s_and_b32 s33, s5, 0xffff
  s_mov_b32 s34, 524288
  s_mov_b32 s35, 0x20000
  v_add_u32 v28, 0, v2
  v_xor_b32 v29, v28, v1
  v_lshlrev_b32 v29, 4, v29
  v_lshl_add_u32 v29, v28, 11, v29
  v_mov_b32 v4, v29
  v_add_u32 v28, 4, v2
  v_xor_b32 v29, v28, v1
  v_lshlrev_b32 v29, 4, v29
  v_lshl_add_u32 v29, v28, 11, v29
  v_subrev_u32 v5, 1024, v29
  v_add_u32 v28, 8, v2
  v_xor_b32 v29, v28, v1
  v_lshlrev_b32 v29, 4, v29
  v_lshl_add_u32 v29, v28, 11, v29
  v_subrev_u32 v6, 2048, v29
  v_add_u32 v28, 12, v2
  v_xor_b32 v29, v28, v1
  v_lshlrev_b32 v29, 4, v29
  v_lshl_add_u32 v29, v28, 11, v29
  v_subrev_u32 v7, 3072, v29
  s_lshl_b32 s71, s18, 2
  v_add_u32 v28, s71, v2
  v_and_b32 v29, 15, v28
  v_xor_b32 v29, v29, v1
  v_lshlrev_b32 v29, 4, v29
  v_lshl_add_u32 v254, v28, 8, v29
  s_lshl_b32 s76, s21, 16
  s_lshl_b32 s77, s19, 13
  s_add_u32 s76, s76, s77
  s_lshl_b32 s77, s18, 10
  s_add_u32 s77, s77, 135168
  s_mov_b32 m0, s77
  s_mov_b32 s52, 0x3e0293ee
  buffer_load_dwordx4 v254, s[32:35], s76 offen lds
  s_nop 0
  s_mov_b32 m0, s101
  s_waitcnt lgkmcnt(0)
  s_min_i32 s49, s49, 0x800
  s_lshl_b32 s55, s55, 15
  s_add_u32 s48, s49, 15
  s_add_u32 s55, s55, s59
  s_ashr_i32 s48, s48, 4
  s_cmp_lt_i32 s68, s48
  s_cbranch_scc0 L_nok0
  buffer_load_dwordx4 v4, s[24:27], s55 offen offset:0 nt lds
  buffer_load_dwordx4 v5, s[24:27], s55 offen offset:1024 nt lds
  buffer_load_dwordx4 v6, s[24:27], s55 offen offset:2048 nt lds
  buffer_load_dwordx4 v7, s[24:27], s55 offen offset:3072 nt lds
L_nok0:
  s_cmp_lt_i32 s36, 49
  s_cbranch_scc1 L_generic
  s_cmp_lt_i32 s37, 33
  s_cbranch_scc1 L_generic
  s_cmp_gt_i32 s37, 1536
  s_cbranch_scc1 L_generic
  s_cmp_lt_i32 s38, 65
  s_cbranch_scc1 L_generic
  s_cmp_lt_i32 s39, 49
  s_cbranch_scc1 L_generic
  s_cmp_lt_i32 s40, 65
  s_cbranch_scc1 L_generic
  s_cmp_lt_i32 s41, 49
  s_cbranch_scc1 L_generic
  s_cmp_lt_i32 s42, 33
  s_cbranch_scc1 L_generic
  s_cmp_gt_i32 s42, 1536
  s_cbranch_scc1 L_generic
  s_cmp_lt_i32 s43, 49
  s_cbranch_scc1 L_generic
  s_lshl_b32 s56, s56, 15
  s_add_u32 s56, s56, s59
  s_lshl_b32 s57, s57, 15
  s_add_u32 s57, s57, s59
  s_lshl_b32 s58, s58, 15
  s_add_u32 s58, s58, s59
  s_branch L_common2
L_common:
  buffer_load_dwordx4 v254, s[32:35], s76 offen lds
  s_nop 0
  s_mov_b32 m0, s101
  s_cmp_lt_u32 s68, s48
  s_cbranch_scc0 L_common2
  buffer_load_dwordx4 v4, s[24:27], s55 offen offset:0 nt lds
  buffer_load_dwordx4 v5, s[24:27], s55 offen offset:1024 nt lds
  buffer_load_dwordx4 v6, s[24:27], s55 offen offset:2048 nt lds
  buffer_load_dwordx4 v7, s[24:27], s55 offen offset:3072 nt lds
L_common2:
  s_lshl_b32 s75, s23, 3
  s_mov_b32 s51, 0
  s_mov_b32 s74, s68
  s_cmp_lt_u32 s74, s48
  s_addc_u32 s51, s51, 0
  s_add_u32 s74, s74, s75
  s_cmp_lt_u32 s74, s48
  s_addc_u32 s51, s51, 0
  s_add_u32 s74, s74, s75
  s_cmp_lt_u32 s74, s48
  s_addc_u32 s51, s51, 0
  s_add_u32 s74, s74, s75
  s_cmp_lt_u32 s74, s48
  s_addc_u32 s51, s51, 0
  s_barrier
  s_cmp_le_u32 s51, 1
  s_cbranch_scc1 L_ik_4
  s_add_u32 s70, s101, 32768
  s_mov_b32 m0, s70
  s_nop 0
  buffer_load_dwordx4 v4, s[24:27], s56 offen offset:0 nt lds
  buffer_load_dwordx4 v5, s[24:27], s56 offen offset:1024 nt lds
  buffer_load_dwordx4 v6, s[24:27], s56 offen offset:2048 nt lds
  buffer_load_dwordx4 v7, s[24:27], s56 offen offset:3072 nt lds
L_ik_4:
L_idone:
  v_add_u32 v28, 0, v2
  v_lshlrev_b32 v29, 1, v2
  v_xor_b32 v29, v29, v1
  v_lshlrev_b32 v29, 4, v29
  v_lshl_add_u32 v29, v28, 11, v29
  v_mov_b32 v8, v29
  v_add_u32 v28, 4, v2
  v_lshlrev_b32 v29, 1, v2
  v_xor_b32 v29, v29, v1
  v_lshlrev_b32 v29, 4, v29
  v_lshl_add_u32 v29, v28, 11, v29
  v_subrev_u32 v9, 1024, v29
  v_add_u32 v28, 8, v2
  v_lshlrev_b32 v29, 1, v2
  v_or_b32 v29, 8, v29
  v_xor_b32 v29, v29, v1
  v_lshlrev_b32 v29, 4, v29
  v_lshl_add_u32 v29, v28, 11, v29
  v_subrev_u32 v10, 2048, v29
  v_add_u32 v28, 12, v2
  v_lshlrev_b32 v29, 1, v2
  v_or_b32 v29, 8, v29
  v_xor_b32 v29, v29, v1
  v_lshlrev_b32 v29, 4, v29
  v_lshl_add_u32 v29, v28, 11, v29
  v_subrev_u32 v11, 3072, v29
  v_add_u32 v28, 0, v2
  v_xor_b32 v28, v28, v1
  v_lshlrev_b32 v28, 4, v28
  v_lshl_add_u32 v28, v1, 8, v28
  v_add_u32 v12, s101, v28
  v_add_u32 v28, 4, v2
  v_xor_b32 v28, v28, v1
  v_lshlrev_b32 v28, 4, v28
  v_lshl_add_u32 v28, v1, 8, v28
  v_add_u32 v13, s101, v28
  v_add_u32 v28, 8, v2
  v_xor_b32 v28, v28, v1
  v_lshlrev_b32 v28, 4, v28
  v_lshl_add_u32 v28, v1, 8, v28
  v_add_u32 v14, s101, v28
  v_add_u32 v28, 12, v2
  v_xor_b32 v28, v28, v1
  v_lshlrev_b32 v28, 4, v28
  v_lshl_add_u32 v28, v1, 8, v28
  v_add_u32 v15, s101, v28
  v_mov_b32 v23, 0xff800000
  v_lshlrev_b32 v25, 2, v2
  v_mul_u32_u24 v28, s23, v0
  v_add_u32 v28, s22, v28
  v_cmp_gt_u32 vcc, s48, v28
  s_lshl_b32 s70, s18, 1
  v_lshrrev_b32 v28, 1, v2
  v_add_u32 v28, s70, v28
  v_xor_b32 v28, v28, v1
  v_lshlrev_b32 v28, 4, v28
  v_lshl_add_u32 v28, v1, 10, v28
  v_and_b32 v29, 1, v2
  v_lshl_add_u32 v28, v29, 3, v28
  v_add_u32 v16, 131072, v28
  s_bcnt1_i32_b32 s50, vcc_lo
  s_add_u32 s66, s50, 7
  s_lshr_b32 s66, s66, 3
  s_add_u32 s67, s50, 1
  s_lshr_b32 s67, s67, 1
  v_add_u32 v28, 0, v2
  v_xor_b32 v28, v28, v1
  v_lshlrev_b32 v28, 4, v28
  v_lshl_add_u32 v28, v1, 10, v28
  v_add_u32 v17, 131072, v28
  v_add_u32 v28, 4, v2
  v_xor_b32 v28, v28, v1
  v_lshlrev_b32 v28, 4, v28
  v_lshl_add_u32 v28, v1, 10, v28
  v_add_u32 v18, 131072, v28
  v_add_u32 v28, 8, v2
  v_xor_b32 v28, v28, v1
  v_lshlrev_b32 v28, 4, v28
  v_lshl_add_u32 v28, v1, 10, v28
  v_add_u32 v19, 131072, v28
  v_add_u32 v28, 12, v2
  v_xor_b32 v28, v28, v1
  v_lshlrev_b32 v28, 4, v28
  v_lshl_add_u32 v28, v1, 10, v28
  v_add_u32 v20, 131072, v28
  v_lshrrev_b32 v28, 2, v1
  v_and_b32 v29, 1, v2
  v_lshl_add_u32 v30, v29, 2, v28
  v_lshl_add_u32 v31, v29, 3, v28
  v_lshlrev_b32 v30, 1, v30
  v_bfe_u32 v28, v1, 1, 1
  s_lshl_b32 s70, s18, 1
  v_add_u32 v28, s70, v28
  v_xor_b32 v28, v28, v30
  v_lshlrev_b32 v28, 4, v28
  v_lshl_add_u32 v28, v31, 8, v28
  v_and_b32 v29, 1, v1
  v_lshl_add_u32 v28, v29, 3, v28
  v_lshrrev_b32 v29, 1, v2
  v_lshl_add_u32 v21, v29, 12, v28
  v_add_u32 v22, 0x10000, v21
  s_cmp_lt_u32 s51, 2
  s_cbranch_scc1 L_lw_6
  s_waitcnt vmcnt(9)
  s_branch L_lw_5
L_lw_6:
  s_cmp_lt_u32 s51, 1
  s_cbranch_scc1 L_lw_7
  s_waitcnt vmcnt(5)
  s_branch L_lw_5
L_lw_7:
  s_waitcnt vmcnt(1)
L_lw_5:
  v_readfirstlane_b32 s53, v3
  s_getreg_b32 s71, hwreg(HW_REG_XCC_ID)
  s_lshl_b32 s70, s53, 3
  s_or_b32 s70, s70, s19
  s_lshl_b32 s70, s70, 3
  s_or_b32 s70, s70, s21
  s_mul_i32 s64, s70, 0x9e3779b1
  s_add_u32 s64, s64, 0x85ebca6b
  s_mul_i32 s65, s70, 0xc2b2ae35
  s_add_u32 s65, s65, 0x27d4eb2f
  s_and_b32 s71, s71, 15
  s_and_b32 s78, s65, 0xffffff00
  s_or_b32 s78, s78, s71
  s_mov_b32 s79, s64
  s_lshl_b32 s72, s19, 3
  s_add_u32 s72, s72, s21
  s_lshl_b32 s72, s72, 6
  s_add_u32 s77, s72, 1024
  s_lshl_b32 s73, s22, 3
  s_add_u32 s73, s73, s77
  s_cmp_eq_u32 s18, 0
  s_cselect_b32 s74, 0, 0x7fffffff
  v_mov_b32 v240, s78
  v_mov_b32 v241, s79
  v_lshlrev_b32 v242, 24, v0
  v_or_b32 v242, s74, v242
  buffer_store_dwordx2 v[240:241], v242, s[44:47], s73 offen sc1
  v_lshlrev_b32 v243, 3, v0
  s_mov_b32 s40, s14
  s_and_b32 s41, s15, 0xffff
  s_mov_b32 s42, 524288
  s_mov_b32 s43, 0x20000
  s_and_b32 s60, s64, 0xfff
  s_bfe_u32 s61, s64, 0xc000c
  s_lshr_b32 s62, s64, 24
  s_lshl_b32 s71, s65, 8
  s_and_b32 s71, s71, 0xf00
  s_or_b32 s62, s62, s71
  s_bfe_u32 s63, s65, 0xc0004
  s_lshl_b32 s70, s21, 16
  s_lshl_b32 s71, s19, 13
  s_add_u32 s70, s70, s71
  s_lshl_b32 s71, s18, 5
  s_add_u32 s70, s70, s71
  v_lshlrev_b32 v254, 8, v1
  v_lshl_add_u32 v254, v2, 3, v254
  v_add_u32 v254, s70, v254
  v_lshlrev_b32 v255, 4, v1
  s_mul_i32 s7, s18, s23
  s_lshl_b32 s71, s23, 3
  s_add_u32 s8, s7, s71
  s_lshr_b32 s7, s7, 4
  s_lshr_b32 s8, s8, 4
  s_mov_b32 s6, 2
  s_cmp_eq_u32 s8, s22
  s_cselect_b32 s6, 1, s6
  s_cmp_eq_u32 s7, s22
  s_cselect_b32 s6, 0, s6
  s_cmp_eq_u32 s6, 2
  s_cselect_b32 s3, 1, 0
  s_cmp_eq_u32 s23, 1
  s_cselect_b32 s3, 1, s3
  s_lshl_b32 s71, 1, s6
  s_and_b32 s59, s71, 3
  s_lshl_b32 s71, 1, s18
  s_and_b32 s71, s71, 3
  s_or_b32 s59, s59, s71
  s_cmp_eq_u32 s23, 1
  s_cselect_b32 s59, 3, s59
  s_mul_i32 s4, s2, 32768
  s_mul_i32 s71, s18, 2048
  s_add_u32 s4, s4, s71
  s_add_u32 s4, s4, 1048576
  s_add_u32 s5, s4, 16384
  s_and_b32 s76, s6, 1
  s_lshl_b32 s72, s54, 3
  s_add_u32 s72, s72, s69
  s_mul_i32 s70, s72, 32768
  s_mul_i32 s73, s76, 16384
  s_add_u32 s70, s70, s73
  s_mul_i32 s73, s18, 2048
  s_add_u32 s70, s70, s73
  s_add_u32 s70, s70, 1048576
  s_lshl_b32 s71, s72, 9
  s_lshl_b32 s73, s76, 8
  s_add_u32 s71, s71, s73
  s_add_u32 s71, s71, 8192
  s_lshl_b32 s73, s76, 12
  v_add_u32 v254, s73, v254
  s_sub_u32 s74, s23, 1
  s_cmp_le_u32 s22, 0
  s_cselect_b32 s72, 1, 0
  s_min_u32 s72, s72, s74
  s_mul_i32 s73, s72, 262144
  s_add_u32 s9, s70, s73
  s_lshl_b32 s73, s72, 12
  s_add_u32 s32, s71, s73
  s_cmp_le_u32 s22, 1
  s_cselect_b32 s72, 2, 1
  s_min_u32 s72, s72, s74
  s_mul_i32 s73, s72, 262144
  s_add_u32 s10, s70, s73
  s_lshl_b32 s73, s72, 12
  s_add_u32 s33, s71, s73
  s_cmp_le_u32 s22, 2
  s_cselect_b32 s72, 3, 2
  s_min_u32 s72, s72, s74
  s_mul_i32 s73, s72, 262144
  s_add_u32 s11, s70, s73
  s_lshl_b32 s73, s72, 12
  s_add_u32 s34, s71, s73
  s_cmp_le_u32 s22, 3
  s_cselect_b32 s72, 4, 3
  s_min_u32 s72, s72, s74
  s_mul_i32 s73, s72, 262144
  s_add_u32 s12, s70, s73
  s_lshl_b32 s73, s72, 12
  s_add_u32 s35, s71, s73
  s_cmp_le_u32 s22, 4
  s_cselect_b32 s72, 5, 4
  s_min_u32 s72, s72, s74
  s_mul_i32 s73, s72, 262144
  s_add_u32 s13, s70, s73
  s_lshl_b32 s73, s72, 12
  s_add_u32 s36, s71, s73
  s_cmp_le_u32 s22, 5
  s_cselect_b32 s72, 6, 5
  s_min_u32 s72, s72, s74
  s_mul_i32 s73, s72, 262144
  s_add_u32 s14, s70, s73
  s_lshl_b32 s73, s72, 12
  s_add_u32 s37, s71, s73
  s_cmp_le_u32 s22, 6
  s_cselect_b32 s72, 7, 6
  s_min_u32 s72, s72, s74
  s_mul_i32 s73, s72, 262144
  s_add_u32 s15, s70, s73
  s_lshl_b32 s73, s72, 12
  s_add_u32 s38, s71, s73
  s_sub_u32 s70, 135168, s101
  v_add_u32 v28, s70, v12
  v_add_u32 v29, s70, v13
  v_add_u32 v30, s70, v14
  v_add_u32 v31, s70, v15
  s_cmp_lt_u32 s51, 2
  s_cbranch_scc1 L_lw_9
  s_waitcnt vmcnt(9)
  s_branch L_lw_8
L_lw_9:
  s_cmp_lt_u32 s51, 1
  s_cbranch_scc1 L_lw_10
  s_waitcnt vmcnt(5)
  s_branch L_lw_8
L_lw_10:
  s_waitcnt vmcnt(1)
L_lw_8:
  s_barrier
  ds_read_b128 v[32:35], v28 offset:0
  ds_read_b128 v[36:39], v29 offset:0
  ds_read_b128 v[40:43], v30 offset:0
  ds_read_b128 v[44:47], v31 offset:0
  ds_read_b128 v[48:51], v28 offset:4096
  ds_read_b128 v[52:55], v29 offset:4096
  ds_read_b128 v[56:59], v30 offset:4096
  ds_read_b128 v[60:63], v31 offset:4096
  s_cmp_ge_u32 s51, 4
  s_cbranch_scc1 L_k4
  s_cmp_ge_u32 s51, 3
  s_cbranch_scc1 L_k3
  s_cmp_ge_u32 s51, 2
  s_cbranch_scc1 L_k2
  s_cmp_ge_u32 s51, 1
  s_cbranch_scc1 L_k1
  s_branch L_k0
L_k4:
  s_waitcnt vmcnt(5)
  ds_read_b128 v[64:67], v12 offset:0
  ds_read_b128 v[68:71], v13 offset:0
  ds_read_b128 v[72:75], v14 offset:0
  ds_read_b128 v[76:79], v15 offset:0
  s_add_u32 s70, s101, 65536
  s_mov_b32 m0, s70
  s_nop 0
  s_waitcnt lgkmcnt(0)
  buffer_load_dwordx4 v4, s[24:27], s57 offen offset:0 nt lds
  buffer_load_dwordx4 v5, s[24:27], s57 offen offset:1024 nt lds
  buffer_load_dwordx4 v6, s[24:27], s57 offen offset:2048 nt lds
  buffer_load_dwordx4 v7, s[24:27], s57 offen offset:3072 nt lds
  v_mfma_f32_16x16x32_bf16 v[80:83], v[64:67], v[32:35], 0
  v_mfma_f32_16x16x32_bf16 v[80:83], v[68:71], v[36:39], v[80:83]
  v_mfma_f32_16x16x32_bf16 v[80:83], v[72:75], v[40:43], v[80:83]
  v_mfma_f32_16x16x32_bf16 v[80:83], v[76:79], v[44:47], v[80:83]
  v_mfma_f32_16x16x32_bf16 v[84:87], v[64:67], v[48:51], 0
  v_mfma_f32_16x16x32_bf16 v[84:87], v[68:71], v[52:55], v[84:87]
  v_mfma_f32_16x16x32_bf16 v[84:87], v[72:75], v[56:59], v[84:87]
  v_mfma_f32_16x16x32_bf16 v[84:87], v[76:79], v[60:63], v[84:87]
  s_waitcnt vmcnt(5)
  ds_read_b128 v[64:67], v12 offset:32768
  ds_read_b128 v[68:71], v13 offset:32768
  ds_read_b128 v[72:75], v14 offset:32768
  ds_read_b128 v[76:79], v15 offset:32768
  s_add_u32 s70, s101, 98304
  s_mov_b32 m0, s70
  s_nop 0
  s_waitcnt lgkmcnt(0)
  buffer_load_dwordx4 v4, s[24:27], s58 offen offset:0 nt lds
  buffer_load_dwordx4 v5, s[24:27], s58 offen offset:1024 nt lds
  buffer_load_dwordx4 v6, s[24:27], s58 offen offset:2048 nt lds
  buffer_load_dwordx4 v7, s[24:27], s58 offen offset:3072 nt lds
  v_mfma_f32_16x16x32_bf16 v[88:91], v[64:67], v[32:35], 0
  v_mfma_f32_16x16x32_bf16 v[88:91], v[68:71], v[36:39], v[88:91]
  v_mfma_f32_16x16x32_bf16 v[88:91], v[72:75], v[40:43], v[88:91]
  v_mfma_f32_16x16x32_bf16 v[88:91], v[76:79], v[44:47], v[88:91]
  v_mfma_f32_16x16x32_bf16 v[92:95], v[64:67], v[48:51], 0
  v_mfma_f32_16x16x32_bf16 v[92:95], v[68:71], v[52:55], v[92:95]
  v_mfma_f32_16x16x32_bf16 v[92:95], v[72:75], v[56:59], v[92:95]
  v_mfma_f32_16x16x32_bf16 v[92:95], v[76:79], v[60:63], v[92:95]
  v_add_u32 v12, 0x10000, v12
  v_add_u32 v13, 0x10000, v13
  v_add_u32 v14, 0x10000, v14
  v_add_u32 v15, 0x10000, v15
  s_waitcnt vmcnt(4)
  ds_read_b128 v[64:67], v12 offset:0
  ds_read_b128 v[68:71], v13 offset:0
  ds_read_b128 v[72:75], v14 offset:0
  ds_read_b128 v[76:79], v15 offset:0
  s_mov_b32 m0, s101
  s_nop 0
  s_waitcnt lgkmcnt(0)
  buffer_load_dwordx2 v[248:249], v243, s[44:47], s77 offen sc1
  buffer_load_dwordx4 v8, s[28:31], s55 offen offset:0 nt lds
  buffer_load_dwordx4 v9, s[28:31], s55 offen offset:1024 nt lds
  buffer_load_dwordx4 v10, s[28:31], s55 offen offset:2048 nt lds
  buffer_load_dwordx4 v11, s[28:31], s55 offen offset:3072 nt lds
  v_mfma_f32_16x16x32_bf16 v[96:99], v[64:67], v[32:35], 0
  v_mfma_f32_16x16x32_bf16 v[96:99], v[68:71], v[36:39], v[96:99]
  v_mfma_f32_16x16x32_bf16 v[96:99], v[72:75], v[40:43], v[96:99]
  v_mfma_f32_16x16x32_bf16 v[96:99], v[76:79], v[44:47], v[96:99]
  v_mfma_f32_16x16x32_bf16 v[100:103], v[64:67], v[48:51], 0
  v_mfma_f32_16x16x32_bf16 v[100:103], v[68:71], v[52:55], v[100:103]
  v_mfma_f32_16x16x32_bf16 v[100:103], v[72:75], v[56:59], v[100:103]
  v_mfma_f32_16x16x32_bf16 v[100:103], v[76:79], v[60:63], v[100:103]
  s_waitcnt vmcnt(5)
  ds_read_b128 v[64:67], v12 offset:32768
  ds_read_b128 v[68:71], v13 offset:32768
  ds_read_b128 v[72:75], v14 offset:32768
  ds_read_b128 v[76:79], v15 offset:32768
  s_add_u32 s70, s101, 32768
  s_mov_b32 m0, s70
  s_nop 0
  s_waitcnt lgkmcnt(0)
  buffer_load_dwordx4 v8, s[28:31], s56 offen offset:0 nt lds
  buffer_load_dwordx4 v9, s[28:31], s56 offen offset:1024 nt lds
  buffer_load_dwordx4 v10, s[28:31], s56 offen offset:2048 nt lds
  buffer_load_dwordx4 v11, s[28:31], s56 offen offset:3072 nt lds
  v_mfma_f32_16x16x32_bf16 v[104:107], v[64:67], v[32:35], 0
  v_mfma_f32_16x16x32_bf16 v[104:107], v[68:71], v[36:39], v[104:107]
  v_mfma_f32_16x16x32_bf16 v[104:107], v[72:75], v[40:43], v[104:107]
  v_mfma_f32_16x16x32_bf16 v[104:107], v[76:79], v[44:47], v[104:107]
  v_mfma_f32_16x16x32_bf16 v[108:111], v[64:67], v[48:51], 0
  v_mfma_f32_16x16x32_bf16 v[108:111], v[68:71], v[52:55], v[108:111]
  v_mfma_f32_16x16x32_bf16 v[108:111], v[72:75], v[56:59], v[108:111]
  v_mfma_f32_16x16x32_bf16 v[108:111], v[76:79], v[60:63], v[108:111]
  s_branch L_kdone
L_k3:
  s_waitcnt vmcnt(5)
  ds_read_b128 v[64:67], v12 offset:0
  ds_read_b128 v[68:71], v13 offset:0
  ds_read_b128 v[72:75], v14 offset:0
  ds_read_b128 v[76:79], v15 offset:0
  s_add_u32 s70, s101, 65536
  s_mov_b32 m0, s70
  s_nop 0
  s_waitcnt lgkmcnt(0)
  buffer_load_dwordx4 v4, s[24:27], s57 offen offset:0 nt lds
  buffer_load_dwordx4 v5, s[24:27], s57 offen offset:1024 nt lds
  buffer_load_dwordx4 v6, s[24:27], s57 offen offset:2048 nt lds
  buffer_load_dwordx4 v7, s[24:27], s57 offen offset:3072 nt lds
  v_mfma_f32_16x16x32_bf16 v[80:83], v[64:67], v[32:35], 0
  v_mfma_f32_16x16x32_bf16 v[80:83], v[68:71], v[36:39], v[80:83]
  v_mfma_f32_16x16x32_bf16 v[80:83], v[72:75], v[40:43], v[80:83]
  v_mfma_f32_16x16x32_bf16 v[80:83], v[76:79], v[44:47], v[80:83]
  v_mfma_f32_16x16x32_bf16 v[84:87], v[64:67], v[48:51], 0
  v_mfma_f32_16x16x32_bf16 v[84:87], v[68:71], v[52:55], v[84:87]
  v_mfma_f32_16x16x32_bf16 v[84:87], v[72:75], v[56:59], v[84:87]
  v_mfma_f32_16x16x32_bf16 v[84:87], v[76:79], v[60:63], v[84:87]
  s_waitcnt vmcnt(5)
  ds_read_b128 v[64:67], v12 offset:32768
  ds_read_b128 v[68:71], v13 offset:32768
  ds_read_b128 v[72:75], v14 offset:32768
  ds_read_b128 v[76:79], v15 offset:32768
  s_mov_b32 m0, s101
  s_nop 0
  s_waitcnt lgkmcnt(0)
  buffer_load_dwordx2 v[248:249], v243, s[44:47], s77 offen sc1
  buffer_load_dwordx4 v8, s[28:31], s55 offen offset:0 nt lds
  buffer_load_dwordx4 v9, s[28:31], s55 offen offset:1024 nt lds
  buffer_load_dwordx4 v10, s[28:31], s55 offen offset:2048 nt lds
  buffer_load_dwordx4 v11, s[28:31], s55 offen offset:3072 nt lds
  v_mfma_f32_16x16x32_bf16 v[88:91], v[64:67], v[32:35], 0
  v_mfma_f32_16x16x32_bf16 v[88:91], v[68:71], v[36:39], v[88:91]
  v_mfma_f32_16x16x32_bf16 v[88:91], v[72:75], v[40:43], v[88:91]
  v_mfma_f32_16x16x32_bf16 v[88:91], v[76:79], v[44:47], v[88:91]
  v_mfma_f32_16x16x32_bf16 v[92:95], v[64:67], v[48:51], 0
  v_mfma_f32_16x16x32_bf16 v[92:95], v[68:71], v[52:55], v[92:95]
  v_mfma_f32_16x16x32_bf16 v[92:95], v[72:75], v[56:59], v[92:95]
  v_mfma_f32_16x16x32_bf16 v[92:95], v[76:79], v[60:63], v[92:95]
  v_add_u32 v12, 0x10000, v12
  v_add_u32 v13, 0x10000, v13
  v_add_u32 v14, 0x10000, v14
  v_add_u32 v15, 0x10000, v15
  s_waitcnt vmcnt(5)
  ds_read_b128 v[64:67], v12 offset:0
  ds_read_b128 v[68:71], v13 offset:0
  ds_read_b128 v[72:75], v14 offset:0
  ds_read_b128 v[76:79], v15 offset:0
  s_add_u32 s70, s101, 32768
  s_mov_b32 m0, s70
  s_nop 0
  s_waitcnt lgkmcnt(0)
  buffer_load_dwordx4 v8, s[28:31], s56 offen offset:0 nt lds
  buffer_load_dwordx4 v9, s[28:31], s56 offen offset:1024 nt lds
  buffer_load_dwordx4 v10, s[28:31], s56 offen offset:2048 nt lds
  buffer_load_dwordx4 v11, s[28:31], s56 offen offset:3072 nt lds
  v_mfma_f32_16x16x32_bf16 v[96:99], v[64:67], v[32:35], 0
  v_mfma_f32_16x16x32_bf16 v[96:99], v[68:71], v[36:39], v[96:99]
  v_mfma_f32_16x16x32_bf16 v[96:99], v[72:75], v[40:43], v[96:99]
  v_mfma_f32_16x16x32_bf16 v[96:99], v[76:79], v[44:47], v[96:99]
  v_mfma_f32_16x16x32_bf16 v[100:103], v[64:67], v[48:51], 0
  v_mfma_f32_16x16x32_bf16 v[100:103], v[68:71], v[52:55], v[100:103]
  v_mfma_f32_16x16x32_bf16 v[100:103], v[72:75], v[56:59], v[100:103]
  v_mfma_f32_16x16x32_bf16 v[100:103], v[76:79], v[60:63], v[100:103]
  s_branch L_kdone
L_k2:
  s_waitcnt vmcnt(5)
  ds_read_b128 v[64:67], v12 offset:0
  ds_read_b128 v[68:71], v13 offset:0
  ds_read_b128 v[72:75], v14 offset:0
  ds_read_b128 v[76:79], v15 offset:0
  s_mov_b32 m0, s101
  s_nop 0
  s_waitcnt lgkmcnt(0)
  buffer_load_dwordx2 v[248:249], v243, s[44:47], s77 offen sc1
  buffer_load_dwordx4 v8, s[28:31], s55 offen offset:0 nt lds
  buffer_load_dwordx4 v9, s[28:31], s55 offen offset:1024 nt lds
  buffer_load_dwordx4 v10, s[28:31], s55 offen offset:2048 nt lds
  buffer_load_dwordx4 v11, s[28:31], s55 offen offset:3072 nt lds
  v_mfma_f32_16x16x32_bf16 v[80:83], v[64:67], v[32:35], 0
  v_mfma_f32_16x16x32_bf16 v[80:83], v[68:71], v[36:39], v[80:83]
  v_mfma_f32_16x16x32_bf16 v[80:83], v[72:75], v[40:43], v[80:83]
  v_mfma_f32_16x16x32_bf16 v[80:83], v[76:79], v[44:47], v[80:83]
  v_mfma_f32_16x16x32_bf16 v[84:87], v[64:67], v[48:51], 0
  v_mfma_f32_16x16x32_bf16 v[84:87], v[68:71], v[52:55], v[84:87]
  v_mfma_f32_16x16x32_bf16 v[84:87], v[72:75], v[56:59], v[84:87]
  v_mfma_f32_16x16x32_bf16 v[84:87], v[76:79], v[60:63], v[84:87]
  s_waitcnt vmcnt(6)
  ds_read_b128 v[64:67], v12 offset:32768
  ds_read_b128 v[68:71], v13 offset:32768
  ds_read_b128 v[72:75], v14 offset:32768
  ds_read_b128 v[76:79], v15 offset:32768
  s_add_u32 s70, s101, 32768
  s_mov_b32 m0, s70
  s_nop 0
  s_waitcnt lgkmcnt(0)
  buffer_load_dwordx4 v8, s[28:31], s56 offen offset:0 nt lds
  buffer_load_dwordx4 v9, s[28:31], s56 offen offset:1024 nt lds
  buffer_load_dwordx4 v10, s[28:31], s56 offen offset:2048 nt lds
  buffer_load_dwordx4 v11, s[28:31], s56 offen offset:3072 nt lds
  v_mfma_f32_16x16x32_bf16 v[88:91], v[64:67], v[32:35], 0
  v_mfma_f32_16x16x32_bf16 v[88:91], v[68:71], v[36:39], v[88:91]
  v_mfma_f32_16x16x32_bf16 v[88:91], v[72:75], v[40:43], v[88:91]
  v_mfma_f32_16x16x32_bf16 v[88:91], v[76:79], v[44:47], v[88:91]
  v_mfma_f32_16x16x32_bf16 v[92:95], v[64:67], v[48:51], 0
  v_mfma_f32_16x16x32_bf16 v[92:95], v[68:71], v[52:55], v[92:95]
  v_mfma_f32_16x16x32_bf16 v[92:95], v[72:75], v[56:59], v[92:95]
  v_mfma_f32_16x16x32_bf16 v[92:95], v[76:79], v[60:63], v[92:95]
  s_branch L_kdone
L_k1:
  s_waitcnt vmcnt(1)
  ds_read_b128 v[64:67], v12 offset:0
  ds_read_b128 v[68:71], v13 offset:0
  ds_read_b128 v[72:75], v14 offset:0
  ds_read_b128 v[76:79], v15 offset:0
  s_mov_b32 m0, s101
  s_nop 0
  s_waitcnt lgkmcnt(0)
  buffer_load_dwordx2 v[248:249], v243, s[44:47], s77 offen sc1
  buffer_load_dwordx4 v8, s[28:31], s55 offen offset:0 nt lds
  buffer_load_dwordx4 v9, s[28:31], s55 offen offset:1024 nt lds
  buffer_load_dwordx4 v10, s[28:31], s55 offen offset:2048 nt lds
  buffer_load_dwordx4 v11, s[28:31], s55 offen offset:3072 nt lds
  v_mfma_f32_16x16x32_bf16 v[80:83], v[64:67], v[32:35], 0
  v_mfma_f32_16x16x32_bf16 v[80:83], v[68:71], v[36:39], v[80:83]
  v_mfma_f32_16x16x32_bf16 v[80:83], v[72:75], v[40:43], v[80:83]
  v_mfma_f32_16x16x32_bf16 v[80:83], v[76:79], v[44:47], v[80:83]
  v_mfma_f32_16x16x32_bf16 v[84:87], v[64:67], v[48:51], 0
  v_mfma_f32_16x16x32_bf16 v[84:87], v[68:71], v[52:55], v[84:87]
  v_mfma_f32_16x16x32_bf16 v[84:87], v[72:75], v[56:59], v[84:87]
  v_mfma_f32_16x16x32_bf16 v[84:87], v[76:79], v[60:63], v[84:87]
  s_branch L_kdone
L_k0:
  buffer_load_dwordx2 v[248:249], v243, s[44:47], s77 offen sc1
  s_waitcnt lgkmcnt(0)
L_kdone:
  s_bitcmp1_b32 s50, 0
  s_cbranch_scc0 L_nozero
  s_and_b32 s70, s50, 7
  s_cmp_lg_u32 s70, s18
  s_cbranch_scc1 L_nozero
  s_lshl_b32 s70, s50, 12
  v_add_u32 v28, s70, v27
  v_mov_b32 v144, 0
  v_mov_b32 v145, 0
  v_mov_b32 v146, 0
  v_mov_b32 v147, 0
  ds_write_b128 v28, v[144:147] offset:0
  ds_write_b128 v28, v[144:147] offset:1024
  ds_write_b128 v28, v[144:147] offset:2048
  ds_write_b128 v28, v[144:147] offset:3072
L_nozero:
  s_lshl_b32 s72, s23, 7
  s_lshl_b32 s70, s68, 4
  s_sub_i32 s70, s49, s70
  v_mov_b32 v244, v23
  v_mov_b32 v245, v23
  s_nop 3
  s_cmp_le_u32 s51, 0
  s_cbranch_scc1 L_maxdone
  s_cmp_ge_i32 s70, 16
  s_cbranch_scc1 L_nomask_11
  s_sub_i32 s71, s70, 0
  v_cmp_le_i32 vcc, s71, v25
  s_nop 1
  v_cndmask_b32 v80, v80, v23, vcc
  v_cndmask_b32 v84, v84, v23, vcc
  s_sub_i32 s71, s70, 1
  v_cmp_le_i32 vcc, s71, v25
  s_nop 1
  v_cndmask_b32 v81, v81, v23, vcc
  v_cndmask_b32 v85, v85, v23, vcc
  s_sub_i32 s71, s70, 2
  v_cmp_le_i32 vcc, s71, v25
  s_nop 1
  v_cndmask_b32 v82, v82, v23, vcc
  v_cndmask_b32 v86, v86, v23, vcc
  s_sub_i32 s71, s70, 3
  v_cmp_le_i32 vcc, s71, v25
  s_nop 1
  v_cndmask_b32 v83, v83, v23, vcc
  v_cndmask_b32 v87, v87, v23, vcc
L_nomask_11:
  v_max3_f32 v244, v244, v80, v81
  v_max3_f32 v245, v245, v84, v85
  v_max3_f32 v244, v244, v82, v83
  v_max3_f32 v245, v245, v86, v87
  s_cmp_le_u32 s51, 1
  s_cbranch_scc1 L_maxdone
  s_sub_i32 s70, s70, s72
  s_cmp_ge_i32 s70, 16
  s_cbranch_scc1 L_nomask_12
  s_sub_i32 s71, s70, 0
  v_cmp_le_i32 vcc, s71, v25
  s_nop 1
  v_cndmask_b32 v88, v88, v23, vcc
  v_cndmask_b32 v92, v92, v23, vcc
  s_sub_i32 s71, s70, 1
  v_cmp_le_i32 vcc, s71, v25
  s_nop 1
  v_cndmask_b32 v89, v89, v23, vcc
  v_cndmask_b32 v93, v93, v23, vcc
  s_sub_i32 s71, s70, 2
  v_cmp_le_i32 vcc, s71, v25
  s_nop 1
  v_cndmask_b32 v90, v90, v23, vcc
  v_cndmask_b32 v94, v94, v23, vcc
  s_sub_i32 s71, s70, 3
  v_cmp_le_i32 vcc, s71, v25
  s_nop 1
  v_cndmask_b32 v91, v91, v23, vcc
  v_cndmask_b32 v95, v95, v23, vcc
L_nomask_12:
  v_max3_f32 v244, v244, v88, v89
  v_max3_f32 v245, v245, v92, v93
  v_max3_f32 v244, v244, v90, v91
  v_max3_f32 v245, v245, v94, v95
  s_cmp_le_u32 s51, 2
  s_cbranch_scc1 L_maxdone
  s_sub_i32 s70, s70, s72
  s_cmp_ge_i32 s70, 16
  s_cbranch_scc1 L_nomask_13
  s_sub_i32 s71, s70, 0
  v_cmp_le_i32 vcc, s71, v25
  s_nop 1
  v_cndmask_b32 v96, v96, v23, vcc
  v_cndmask_b32 v100, v100, v23, vcc
  s_sub_i32 s71, s70, 1
  v_cmp_le_i32 vcc, s71, v25
  s_nop 1
  v_cndmask_b32 v97, v97, v23, vcc
  v_cndmask_b32 v101, v101, v23, vcc
  s_sub_i32 s71, s70, 2
  v_cmp_le_i32 vcc, s71, v25
  s_nop 1
  v_cndmask_b32 v98, v98, v23, vcc
  v_cndmask_b32 v102, v102, v23, vcc
  s_sub_i32 s71, s70, 3
  v_cmp_le_i32 vcc, s71, v25
  s_nop 1
  v_cndmask_b32 v99, v99, v23, vcc
  v_cndmask_b32 v103, v103, v23, vcc
L_nomask_13:
  v_max3_f32 v244, v244, v96, v97
  v_max3_f32 v245, v245, v100, v101
  v_max3_f32 v244, v244, v98, v99
  v_max3_f32 v245, v245, v102, v103
  s_cmp_le_u32 s51, 3
  s_cbranch_scc1 L_maxdone
  s_sub_i32 s70, s70, s72
  s_cmp_ge_i32 s70, 16
  s_cbranch_scc1 L_nomask_14
  s_sub_i32 s71, s70, 0
  v_cmp_le_i32 vcc, s71, v25
  s_nop 1
  v_cndmask_b32 v104, v104, v23, vcc
  v_cndmask_b32 v108, v108, v23, vcc
  s_sub_i32 s71, s70, 1
  v_cmp_le_i32 vcc, s71, v25
  s_nop 1
  v_cndmask_b32 v105, v105, v23, vcc
  v_cndmask_b32 v109, v109, v23, vcc
  s_sub_i32 s71, s70, 2
  v_cmp_le_i32 vcc, s71, v25
  s_nop 1
  v_cndmask_b32 v106, v106, v23, vcc
  v_cndmask_b32 v110, v110, v23, vcc
  s_sub_i32 s71, s70, 3
  v_cmp_le_i32 vcc, s71, v25
  s_nop 1
  v_cndmask_b32 v107, v107, v23, vcc
  v_cndmask_b32 v111, v111, v23, vcc
L_nomask_14:
  v_max3_f32 v244, v244, v104, v105
  v_max3_f32 v245, v245, v108, v109
  v_max3_f32 v244, v244, v106, v107
  v_max3_f32 v245, v245, v110, v111
L_maxdone:
  v_mov_b32 v246, v244
  v_mov_b32 v247, v245
  s_nop 1
  v_permlane32_swap_b32 v244, v246
  v_permlane32_swap_b32 v245, v247
  s_nop 0
  v_max_f32 v244, v244, v246
  v_max_f32 v245, v245, v247
  v_mov_b32 v246, v244
  v_mov_b32 v247, v245
  s_nop 1
  v_permlane16_swap_b32 v244, v246
  v_permlane16_swap_b32 v245, v247
  s_nop 0
  v_max_f32 v244, v244, v246
  v_max_f32 v245, v245, v247
  s_lshl_b32 s70, s18, 2
  s_add_u32 s70, s70, 143360
  v_lshl_add_u32 v28, v1, 5, s70
  ds_write_b32 v28, v244
  ds_write_b32 v28, v245 offset:512
  v_lshlrev_b32 v29, 5, v1
  v_add_u32 v29, 143360, v29
  s_waitcnt lgkmcnt(0)
  s_barrier
  ds_read_b128 v[112:115], v29 offset:0
  ds_read_b128 v[116:119], v29 offset:16
  ds_read_b128 v[120:123], v29 offset:512
  ds_read_b128 v[124:127], v29 offset:528
  s_waitcnt lgkmcnt(0)
  s_barrier
  v_max3_f32 v112, v112, v113, v114
  v_max3_f32 v115, v115, v116, v117
  v_max3_f32 v120, v120, v121, v122
  v_max3_f32 v123, v123, v124, v125
  v_max3_f32 v112, v112, v118, v119
  v_max3_f32 v120, v120, v126, v127
  v_max_f32 v112, v112, v115
  v_max_f32 v120, v120, v123
  v_mul_f32 v24, s52, v112
  v_mul_f32 v26, s52, v120
  v_mov_b32 v244, 0
  v_mov_b32 v245, 0
  s_cmp_le_u32 s51, 0
  s_cbranch_scc1 L_pz_15
  v_pk_fma_f32 v[80:81], v[80:81], s[52:53], v[24:25] op_sel_hi:[1,0,0] neg_lo:[0,0,1] neg_hi:[0,0,1]
  v_pk_fma_f32 v[82:83], v[82:83], s[52:53], v[24:25] op_sel_hi:[1,0,0] neg_lo:[0,0,1] neg_hi:[0,0,1]
  v_pk_fma_f32 v[84:85], v[84:85], s[52:53], v[26:27] op_sel_hi:[1,0,0] neg_lo:[0,0,1] neg_hi:[0,0,1]
  v_pk_fma_f32 v[86:87], v[86:87], s[52:53], v[26:27] op_sel_hi:[1,0,0] neg_lo:[0,0,1] neg_hi:[0,0,1]
  v_exp_f32 v80, v80
  v_exp_f32 v81, v81
  v_exp_f32 v82, v82
  v_exp_f32 v83, v83
  v_exp_f32 v84, v84
  v_exp_f32 v85, v85
  v_exp_f32 v86, v86
  v_exp_f32 v87, v87
  s_nop 0
  v_cvt_pk_bf16_f32 v80, v80, v81
  v_cvt_pk_bf16_f32 v81, v82, v83
  v_cvt_pk_bf16_f32 v84, v84, v85
  v_cvt_pk_bf16_f32 v85, v86, v87
  ds_write_b64 v16, v[80:81] offset:0
  ds_write_b64 v16, v[84:85] offset:16384
  s_branch L_pd_16
L_pz_15:
  ds_write_b64 v16, v[244:245] offset:0
  ds_write_b64 v16, v[244:245] offset:16384
L_pd_16:
  s_cmp_le_u32 s51, 1
  s_cbranch_scc1 L_pz_17
  v_pk_fma_f32 v[88:89], v[88:89], s[52:53], v[24:25] op_sel_hi:[1,0,0] neg_lo:[0,0,1] neg_hi:[0,0,1]
  v_pk_fma_f32 v[90:91], v[90:91], s[52:53], v[24:25] op_sel_hi:[1,0,0] neg_lo:[0,0,1] neg_hi:[0,0,1]
  v_pk_fma_f32 v[92:93], v[92:93], s[52:53], v[26:27] op_sel_hi:[1,0,0] neg_lo:[0,0,1] neg_hi:[0,0,1]
  v_pk_fma_f32 v[94:95], v[94:95], s[52:53], v[26:27] op_sel_hi:[1,0,0] neg_lo:[0,0,1] neg_hi:[0,0,1]
  v_exp_f32 v88, v88
  v_exp_f32 v89, v89
  v_exp_f32 v90, v90
  v_exp_f32 v91, v91
  v_exp_f32 v92, v92
  v_exp_f32 v93, v93
  v_exp_f32 v94, v94
  v_exp_f32 v95, v95
  s_nop 0
  v_cvt_pk_bf16_f32 v88, v88, v89
  v_cvt_pk_bf16_f32 v89, v90, v91
  v_cvt_pk_bf16_f32 v92, v92, v93
  v_cvt_pk_bf16_f32 v93, v94, v95
  ds_write_b64 v16, v[88:89] offset:256
  ds_write_b64 v16, v[92:93] offset:16640
  s_branch L_pd_18
L_pz_17:
  ds_write_b64 v16, v[244:245] offset:256
  ds_write_b64 v16, v[244:245] offset:16640
L_pd_18:
  s_cmp_le_u32 s51, 2
  s_cbranch_scc1 L_pz_19
  v_pk_fma_f32 v[96:97], v[96:97], s[52:53], v[24:25] op_sel_hi:[1,0,0] neg_lo:[0,0,1] neg_hi:[0,0,1]
  v_pk_fma_f32 v[98:99], v[98:99], s[52:53], v[24:25] op_sel_hi:[1,0,0] neg_lo:[0,0,1] neg_hi:[0,0,1]
  v_pk_fma_f32 v[100:101], v[100:101], s[52:53], v[26:27] op_sel_hi:[1,0,0] neg_lo:[0,0,1] neg_hi:[0,0,1]
  v_pk_fma_f32 v[102:103], v[102:103], s[52:53], v[26:27] op_sel_hi:[1,0,0] neg_lo:[0,0,1] neg_hi:[0,0,1]
  v_exp_f32 v96, v96
  v_exp_f32 v97, v97
  v_exp_f32 v98, v98
  v_exp_f32 v99, v99
  v_exp_f32 v100, v100
  v_exp_f32 v101, v101
  v_exp_f32 v102, v102
  v_exp_f32 v103, v103
  s_nop 0
  v_cvt_pk_bf16_f32 v96, v96, v97
  v_cvt_pk_bf16_f32 v97, v98, v99
  v_cvt_pk_bf16_f32 v100, v100, v101
  v_cvt_pk_bf16_f32 v101, v102, v103
  ds_write_b64 v16, v[96:97] offset:512
  ds_write_b64 v16, v[100:101] offset:16896
  s_branch L_pd_20
L_pz_19:
  ds_write_b64 v16, v[244:245] offset:512
  ds_write_b64 v16, v[244:245] offset:16896
L_pd_20:
  s_cmp_le_u32 s51, 3
  s_cbranch_scc1 L_pz_21
  v_pk_fma_f32 v[104:105], v[104:105], s[52:53], v[24:25] op_sel_hi:[1,0,0] neg_lo:[0,0,1] neg_hi:[0,0,1]
  v_pk_fma_f32 v[106:107], v[106:107], s[52:53], v[24:25] op_sel_hi:[1,0,0] neg_lo:[0,0,1] neg_hi:[0,0,1]
  v_pk_fma_f32 v[108:109], v[108:109], s[52:53], v[26:27] op_sel_hi:[1,0,0] neg_lo:[0,0,1] neg_hi:[0,0,1]
  v_pk_fma_f32 v[110:111], v[110:111], s[52:53], v[26:27] op_sel_hi:[1,0,0] neg_lo:[0,0,1] neg_hi:[0,0,1]
  v_exp_f32 v104, v104
  v_exp_f32 v105, v105
  v_exp_f32 v106, v106
  v_exp_f32 v107, v107
  v_exp_f32 v108, v108
  v_exp_f32 v109, v109
  v_exp_f32 v110, v110
  v_exp_f32 v111, v111
  s_nop 0
  v_cvt_pk_bf16_f32 v104, v104, v105
  v_cvt_pk_bf16_f32 v105, v106, v107
  v_cvt_pk_bf16_f32 v108, v108, v109
  v_cvt_pk_bf16_f32 v109, v110, v111
  ds_write_b64 v16, v[104:105] offset:768
  ds_write_b64 v16, v[108:109] offset:17152
  s_branch L_pd_22
L_pz_21:
  ds_write_b64 v16, v[244:245] offset:768
  ds_write_b64 v16, v[244:245] offset:17152
L_pd_22:
  v_mov_b32 v64, 0x3f803f80
  v_mov_b32 v65, 0x3f803f80
  v_mov_b32 v66, 0x3f803f80
  v_mov_b32 v67, 0x3f803f80
  s_cmp_le_u32 s51, 1
  s_cbranch_scc1 L_vw_23
  s_waitcnt vmcnt(4)
  s_branch L_vw_24
L_vw_23:
  s_waitcnt vmcnt(0)
L_vw_24:
  v_cmp_eq_u64 vcc, s[78:79], v[248:249]
  s_lshl_b32 s71, 1, s23
  s_sub_u32 s71, s71, 1
  s_nop 2
  s_and_b32 s72, vcc_lo, s71
  s_cmp_eq_u32 s72, s71
  s_cselect_b32 s100, 1, 0
  s_cmp_gt_u32 s23, 5
  s_cselect_b32 s3, 0, s100
  s_mul_i32 s71, s100, 3
  s_cmp_eq_u32 s6, 2
  s_cselect_b32 s3, s71, s3
  s_cmp_eq_u32 s23, 1
  s_cselect_b32 s3, 0, s3
  v_mov_b32 v75, 0xfffff000
  s_cmp_le_u32 s51, 2
  s_cbranch_scc1 L_vn_25
  s_add_u32 s70, s101, 65536
  s_mov_b32 m0, s70
  s_nop 0
  buffer_load_dwordx4 v8, s[28:31], s57 offen offset:0 nt lds
  buffer_load_dwordx4 v9, s[28:31], s57 offen offset:1024 nt lds
  buffer_load_dwordx4 v10, s[28:31], s57 offen offset:2048 nt lds
  buffer_load_dwordx4 v11, s[28:31], s57 offen offset:3072 nt lds
L_vn_25:
  s_waitcnt lgkmcnt(0)
  s_barrier
  s_cmp_lt_u32 s66, 3
  s_cbranch_scc1 L_pold
  ds_read_b128 v[112:115], v17 offset:0
  ds_read_b128 v[116:119], v17 offset:16384
  ds_read_b128 v[120:123], v18 offset:0
  ds_read_b128 v[124:127], v18 offset:16384
  ds_read_b128 v[128:131], v19 offset:0
  ds_read_b128 v[132:135], v19 offset:16384
  ds_read_b128 v[136:139], v20 offset:0
  ds_read_b128 v[140:143], v20 offset:16384
  ds_read_b64_tr_b16 v[32:33], v21 offset:0
  ds_read_b64_tr_b16 v[34:35], v21 offset:1024
  ds_read_b64_tr_b16 v[36:37], v21 offset:8192
  ds_read_b64_tr_b16 v[38:39], v21 offset:9216
  ds_read_b64_tr_b16 v[40:41], v21 offset:16384
  ds_read_b64_tr_b16 v[42:43], v21 offset:17408
  ds_read_b64_tr_b16 v[44:45], v21 offset:24576
  ds_read_b64_tr_b16 v[46:47], v21 offset:25600
  ds_read_b128 v[144:147], v17 offset:256
  ds_read_b128 v[148:151], v17 offset:16640
  ds_read_b128 v[152:155], v18 offset:256
  ds_read_b128 v[156:159], v18 offset:16640
  ds_read_b128 v[160:163], v19 offset:256
  ds_read_b128 v[164:167], v19 offset:16640
  ds_read_b128 v[168:171], v20 offset:256
  ds_read_b128 v[172:175], v20 offset:16640
  s_waitcnt lgkmcnt(8)
  v_mfma_f32_16x16x32_bf16 v[48:51], v[32:35], v[112:115], 0
  v_mfma_f32_16x16x32_bf16 v[52:55], v[32:35], v[116:119], 0
  v_mfma_f32_16x16x32_bf16 v[48:51], v[36:39], v[120:123], v[48:51]
  v_mfma_f32_16x16x32_bf16 v[52:55], v[36:39], v[124:127], v[52:55]
  v_mfma_f32_16x16x32_bf16 v[48:51], v[40:43], v[128:131], v[48:51]
  v_mfma_f32_16x16x32_bf16 v[52:55], v[40:43], v[132:135], v[52:55]
  v_mfma_f32_16x16x32_bf16 v[48:51], v[44:47], v[136:139], v[48:51]
  v_mfma_f32_16x16x32_bf16 v[52:55], v[44:47], v[140:143], v[52:55]
  s_bitcmp0_b32 s59, 0
  s_cbranch_scc1 L_ls_26
  v_mfma_f32_16x16x32_bf16 v[56:59], v[64:67], v[112:115], 0
  v_mfma_f32_16x16x32_bf16 v[56:59], v[64:67], v[120:123], v[56:59]
  v_mfma_f32_16x16x32_bf16 v[56:59], v[64:67], v[128:131], v[56:59]
  v_mfma_f32_16x16x32_bf16 v[56:59], v[64:67], v[136:139], v[56:59]
L_ls_26:
  s_bitcmp0_b32 s59, 1
  s_cbranch_scc1 L_ls_27
  v_mfma_f32_16x16x32_bf16 v[60:63], v[64:67], v[116:119], 0
  v_mfma_f32_16x16x32_bf16 v[60:63], v[64:67], v[124:127], v[60:63]
  v_mfma_f32_16x16x32_bf16 v[60:63], v[64:67], v[132:135], v[60:63]
  v_mfma_f32_16x16x32_bf16 v[60:63], v[64:67], v[140:143], v[60:63]
L_ls_27:
  s_cmp_le_u32 s51, 2
  s_cbranch_scc1 L_vw_28
  s_waitcnt vmcnt(4)
  s_branch L_vw_29
L_vw_28:
  s_waitcnt vmcnt(0)
L_vw_29:
  s_cmp_le_u32 s51, 3
  s_cbranch_scc1 L_vn_30
  s_add_u32 s70, s101, 98304
  s_mov_b32 m0, s70
  s_nop 0
  buffer_load_dwordx4 v8, s[28:31], s58 offen offset:0 nt lds
  buffer_load_dwordx4 v9, s[28:31], s58 offen offset:1024 nt lds
  buffer_load_dwordx4 v10, s[28:31], s58 offen offset:2048 nt lds
  buffer_load_dwordx4 v11, s[28:31], s58 offen offset:3072 nt lds
L_vn_30:
  s_barrier
  ds_read_b64_tr_b16 v[32:33], v21 offset:32768
  ds_read_b64_tr_b16 v[34:35], v21 offset:33792
  ds_read_b64_tr_b16 v[36:37], v21 offset:40960
  ds_read_b64_tr_b16 v[38:39], v21 offset:41984
  ds_read_b64_tr_b16 v[40:41], v21 offset:49152
  ds_read_b64_tr_b16 v[42:43], v21 offset:50176
  ds_read_b64_tr_b16 v[44:45], v21 offset:57344
  ds_read_b64_tr_b16 v[46:47], v21 offset:58368
  ds_read_b128 v[176:179], v17 offset:512
  ds_read_b128 v[180:183], v17 offset:16896
  ds_read_b128 v[184:187], v18 offset:512
  ds_read_b128 v[188:191], v18 offset:16896
  ds_read_b128 v[192:195], v19 offset:512
  ds_read_b128 v[196:199], v19 offset:16896
  ds_read_b128 v[200:203], v20 offset:512
  ds_read_b128 v[204:207], v20 offset:16896
  s_waitcnt lgkmcnt(8)
  v_mfma_f32_16x16x32_bf16 v[48:51], v[32:35], v[144:147], v[48:51]
  v_mfma_f32_16x16x32_bf16 v[52:55], v[32:35], v[148:151], v[52:55]
  v_mfma_f32_16x16x32_bf16 v[48:51], v[36:39], v[152:155], v[48:51]
  v_mfma_f32_16x16x32_bf16 v[52:55], v[36:39], v[156:159], v[52:55]
  v_mfma_f32_16x16x32_bf16 v[48:51], v[40:43], v[160:163], v[48:51]
  v_mfma_f32_16x16x32_bf16 v[52:55], v[40:43], v[164:167], v[52:55]
  v_mfma_f32_16x16x32_bf16 v[48:51], v[44:47], v[168:171], v[48:51]
  v_mfma_f32_16x16x32_bf16 v[52:55], v[44:47], v[172:175], v[52:55]
  s_bitcmp0_b32 s59, 0
  s_cbranch_scc1 L_ls_31
  v_mfma_f32_16x16x32_bf16 v[56:59], v[64:67], v[144:147], v[56:59]
  v_mfma_f32_16x16x32_bf16 v[56:59], v[64:67], v[152:155], v[56:59]
  v_mfma_f32_16x16x32_bf16 v[56:59], v[64:67], v[160:163], v[56:59]
  v_mfma_f32_16x16x32_bf16 v[56:59], v[64:67], v[168:171], v[56:59]
L_ls_31:
  s_bitcmp0_b32 s59, 1
  s_cbranch_scc1 L_ls_32
  v_mfma_f32_16x16x32_bf16 v[60:63], v[64:67], v[148:151], v[60:63]
  v_mfma_f32_16x16x32_bf16 v[60:63], v[64:67], v[156:159], v[60:63]
  v_mfma_f32_16x16x32_bf16 v[60:63], v[64:67], v[164:167], v[60:63]
  v_mfma_f32_16x16x32_bf16 v[60:63], v[64:67], v[172:175], v[60:63]
L_ls_32:
  s_cmp_le_u32 s66, 3
  s_cbranch_scc1 L_p3_33
  ds_read_b128 v[208:211], v17 offset:768
  ds_read_b128 v[212:215], v17 offset:17152
  ds_read_b128 v[216:219], v18 offset:768
  ds_read_b128 v[220:223], v18 offset:17152
  ds_read_b128 v[224:227], v19 offset:768
  ds_read_b128 v[228:231], v19 offset:17152
  ds_read_b128 v[232:235], v20 offset:768
  ds_read_b128 v[236:239], v20 offset:17152
  s_waitcnt lgkmcnt(8)
  s_bitcmp0_b32 s59, 0
  s_cbranch_scc1 L_ls_34
  v_mfma_f32_16x16x32_bf16 v[56:59], v[64:67], v[176:179], v[56:59]
  v_mfma_f32_16x16x32_bf16 v[56:59], v[64:67], v[184:187], v[56:59]
  v_mfma_f32_16x16x32_bf16 v[56:59], v[64:67], v[192:195], v[56:59]
  v_mfma_f32_16x16x32_bf16 v[56:59], v[64:67], v[200:203], v[56:59]
L_ls_34:
  s_bitcmp0_b32 s59, 1
  s_cbranch_scc1 L_ls_35
  v_mfma_f32_16x16x32_bf16 v[60:63], v[64:67], v[180:183], v[60:63]
  v_mfma_f32_16x16x32_bf16 v[60:63], v[64:67], v[188:191], v[60:63]
  v_mfma_f32_16x16x32_bf16 v[60:63], v[64:67], v[196:199], v[60:63]
  v_mfma_f32_16x16x32_bf16 v[60:63], v[64:67], v[204:207], v[60:63]
L_ls_35:
  s_waitcnt lgkmcnt(0)
  s_bitcmp0_b32 s59, 0
  s_cbranch_scc1 L_ls_36
  v_mfma_f32_16x16x32_bf16 v[56:59], v[64:67], v[208:211], v[56:59]
  v_mfma_f32_16x16x32_bf16 v[56:59], v[64:67], v[216:219], v[56:59]
  v_mfma_f32_16x16x32_bf16 v[56:59], v[64:67], v[224:227], v[56:59]
  v_mfma_f32_16x16x32_bf16 v[56:59], v[64:67], v[232:235], v[56:59]
L_ls_36:
  s_bitcmp0_b32 s59, 1
  s_cbranch_scc1 L_ls_37
  v_mfma_f32_16x16x32_bf16 v[60:63], v[64:67], v[212:215], v[60:63]
  v_mfma_f32_16x16x32_bf16 v[60:63], v[64:67], v[220:223], v[60:63]
  v_mfma_f32_16x16x32_bf16 v[60:63], v[64:67], v[228:231], v[60:63]
  v_mfma_f32_16x16x32_bf16 v[60:63], v[64:67], v[236:239], v[60:63]
L_ls_37:
  s_branch L_p3done
L_p3_33:
  s_waitcnt lgkmcnt(0)
  s_bitcmp0_b32 s59, 0
  s_cbranch_scc1 L_ls_38
  v_mfma_f32_16x16x32_bf16 v[56:59], v[64:67], v[176:179], v[56:59]
  v_mfma_f32_16x16x32_bf16 v[56:59], v[64:67], v[184:187], v[56:59]
  v_mfma_f32_16x16x32_bf16 v[56:59], v[64:67], v[192:195], v[56:59]
  v_mfma_f32_16x16x32_bf16 v[56:59], v[64:67], v[200:203], v[56:59]
L_ls_38:
  s_bitcmp0_b32 s59, 1
  s_cbranch_scc1 L_ls_39
  v_mfma_f32_16x16x32_bf16 v[60:63], v[64:67], v[180:183], v[60:63]
  v_mfma_f32_16x16x32_bf16 v[60:63], v[64:67], v[188:191], v[60:63]
  v_mfma_f32_16x16x32_bf16 v[60:63], v[64:67], v[196:199], v[60:63]
  v_mfma_f32_16x16x32_bf16 v[60:63], v[64:67], v[204:207], v[60:63]
L_ls_39:
L_p3done:
  s_cmp_eq_u32 s23, 1
  s_cbranch_scc1 L_nomlc
  s_nop 3
  s_cmp_gt_u32 s18, 1
  s_cbranch_scc1 L_nomlc
  s_lshl_b32 s71, s2, 9
  s_lshl_b32 s72, s18, 8
  s_add_u32 s71, s71, s72
  s_add_u32 s71, s71, 8192
  s_cmp_eq_u32 s18, 0
  s_cselect_b64 vcc, -1, 0
  s_nop 3
  v_cndmask_b32 v240, v26, v24, vcc
  v_cndmask_b32 v241, v60, v56, vcc
  v_mov_b32 v242, s64
  v_mov_b32 v243, s65
  s_mov_b64 exec, 0xffff
  s_cmp_eq_u32 s100, 0
  s_cbranch_scc1 L_mlsc1c
  buffer_store_dwordx4 v[240:243], v27, s[44:47], s71 offen
  s_branch L_mlokc
L_mlsc1c:
  buffer_store_dwordx4 v[240:243], v27, s[44:47], s71 offen sc1
L_mlokc:
  s_mov_b64 exec, -1
L_nomlc:
  s_branch L_stage2
L_pold:
  ds_read_b128 v[112:115], v17 offset:0
  ds_read_b128 v[116:119], v17 offset:16384
  ds_read_b128 v[120:123], v18 offset:0
  ds_read_b128 v[124:127], v18 offset:16384
  ds_read_b128 v[128:131], v19 offset:0
  ds_read_b128 v[132:135], v19 offset:16384
  ds_read_b128 v[136:139], v20 offset:0
  ds_read_b128 v[140:143], v20 offset:16384
  s_cmp_le_u32 s66, 1
  s_cbranch_scc1 L_pdone
  ds_read_b128 v[144:147], v17 offset:256
  ds_read_b128 v[148:151], v17 offset:16640
  ds_read_b128 v[152:155], v18 offset:256
  ds_read_b128 v[156:159], v18 offset:16640
  ds_read_b128 v[160:163], v19 offset:256
  ds_read_b128 v[164:167], v19 offset:16640
  ds_read_b128 v[168:171], v20 offset:256
  ds_read_b128 v[172:175], v20 offset:16640
  s_cmp_le_u32 s66, 2
  s_cbranch_scc1 L_pdone
  ds_read_b128 v[176:179], v17 offset:512
  ds_read_b128 v[180:183], v17 offset:16896
  ds_read_b128 v[184:187], v18 offset:512
  ds_read_b128 v[188:191], v18 offset:16896
  ds_read_b128 v[192:195], v19 offset:512
  ds_read_b128 v[196:199], v19 offset:16896
  ds_read_b128 v[200:203], v20 offset:512
  ds_read_b128 v[204:207], v20 offset:16896
  s_cmp_le_u32 s66, 3
  s_cbranch_scc1 L_pdone
  ds_read_b128 v[208:211], v17 offset:768
  ds_read_b128 v[212:215], v17 offset:17152
  ds_read_b128 v[216:219], v18 offset:768
  ds_read_b128 v[220:223], v18 offset:17152
  ds_read_b128 v[224:227], v19 offset:768
  ds_read_b128 v[228:231], v19 offset:17152
  ds_read_b128 v[232:235], v20 offset:768
  ds_read_b128 v[236:239], v20 offset:17152
L_pdone:
  s_waitcnt lgkmcnt(0)
  s_cmp_eq_u32 s6, 0
  s_cbranch_scc1 L_ldo_41
  s_cmp_eq_u32 s18, 0
  s_cbranch_scc1 L_ldo_41
  s_cmp_lg_u32 s23, 1
  s_cbranch_scc1 L_lskip_40
L_ldo_41:
  v_mfma_f32_16x16x32_bf16 v[56:59], v[64:67], v[112:115], 0
  v_mfma_f32_16x16x32_bf16 v[56:59], v[64:67], v[120:123], v[56:59]
  v_mfma_f32_16x16x32_bf16 v[56:59], v[64:67], v[128:131], v[56:59]
  v_mfma_f32_16x16x32_bf16 v[56:59], v[64:67], v[136:139], v[56:59]
  s_cmp_le_u32 s66, 1
  s_cbranch_scc1 L_lskip_40
  v_mfma_f32_16x16x32_bf16 v[56:59], v[64:67], v[144:147], v[56:59]
  v_mfma_f32_16x16x32_bf16 v[56:59], v[64:67], v[152:155], v[56:59]
  v_mfma_f32_16x16x32_bf16 v[56:59], v[64:67], v[160:163], v[56:59]
  v_mfma_f32_16x16x32_bf16 v[56:59], v[64:67], v[168:171], v[56:59]
  s_cmp_le_u32 s66, 2
  s_cbranch_scc1 L_lskip_40
  v_mfma_f32_16x16x32_bf16 v[56:59], v[64:67], v[176:179], v[56:59]
  v_mfma_f32_16x16x32_bf16 v[56:59], v[64:67], v[184:187], v[56:59]
  v_mfma_f32_16x16x32_bf16 v[56:59], v[64:67], v[192:195], v[56:59]
  v_mfma_f32_16x16x32_bf16 v[56:59], v[64:67], v[200:203], v[56:59]
  s_cmp_le_u32 s66, 3
  s_cbranch_scc1 L_lskip_40
  v_mfma_f32_16x16x32_bf16 v[56:59], v[64:67], v[208:211], v[56:59]
  v_mfma_f32_16x16x32_bf16 v[56:59], v[64:67], v[216:219], v[56:59]
  v_mfma_f32_16x16x32_bf16 v[56:59], v[64:67], v[224:227], v[56:59]
  v_mfma_f32_16x16x32_bf16 v[56:59], v[64:67], v[232:235], v[56:59]
L_lskip_40:
  s_cmp_eq_u32 s6, 1
  s_cbranch_scc1 L_ldo_43
  s_cmp_eq_u32 s18, 1
  s_cbranch_scc1 L_ldo_43
  s_cmp_lg_u32 s23, 1
  s_cbranch_scc1 L_lskip_42
L_ldo_43:
  v_mfma_f32_16x16x32_bf16 v[60:63], v[64:67], v[116:119], 0
  v_mfma_f32_16x16x32_bf16 v[60:63], v[64:67], v[124:127], v[60:63]
  v_mfma_f32_16x16x32_bf16 v[60:63], v[64:67], v[132:135], v[60:63]
  v_mfma_f32_16x16x32_bf16 v[60:63], v[64:67], v[140:143], v[60:63]
  s_cmp_le_u32 s66, 1
  s_cbranch_scc1 L_lskip_42
  v_mfma_f32_16x16x32_bf16 v[60:63], v[64:67], v[148:151], v[60:63]
  v_mfma_f32_16x16x32_bf16 v[60:63], v[64:67], v[156:159], v[60:63]
  v_mfma_f32_16x16x32_bf16 v[60:63], v[64:67], v[164:167], v[60:63]
  v_mfma_f32_16x16x32_bf16 v[60:63], v[64:67], v[172:175], v[60:63]
  s_cmp_le_u32 s66, 2
  s_cbranch_scc1 L_lskip_42
  v_mfma_f32_16x16x32_bf16 v[60:63], v[64:67], v[180:183], v[60:63]
  v_mfma_f32_16x16x32_bf16 v[60:63], v[64:67], v[188:191], v[60:63]
  v_mfma_f32_16x16x32_bf16 v[60:63], v[64:67], v[196:199], v[60:63]
  v_mfma_f32_16x16x32_bf16 v[60:63], v[64:67], v[204:207], v[60:63]
  s_cmp_le_u32 s66, 3
  s_cbranch_scc1 L_lskip_42
  v_mfma_f32_16x16x32_bf16 v[60:63], v[64:67], v[212:215], v[60:63]
  v_mfma_f32_16x16x32_bf16 v[60:63], v[64:67], v[220:223], v[60:63]
  v_mfma_f32_16x16x32_bf16 v[60:63], v[64:67], v[228:231], v[60:63]
  v_mfma_f32_16x16x32_bf16 v[60:63], v[64:67], v[236:239], v[60:63]
L_lskip_42:
  s_cmp_lt_u32 s67, 4
  s_cbranch_scc1 L_part_45
  ds_read_b64_tr_b16 v[32:33], v21 offset:0
  ds_read_b64_tr_b16 v[34:35], v21 offset:1024
  ds_read_b64_tr_b16 v[36:37], v21 offset:8192
  ds_read_b64_tr_b16 v[38:39], v21 offset:9216
  ds_read_b64_tr_b16 v[40:41], v21 offset:16384
  ds_read_b64_tr_b16 v[42:43], v21 offset:17408
  ds_read_b64_tr_b16 v[44:45], v21 offset:24576
  ds_read_b64_tr_b16 v[46:47], v21 offset:25600
  s_waitcnt lgkmcnt(6)
  v_mfma_f32_16x16x32_bf16 v[48:51], v[32:35], v[112:115], 0
  v_mfma_f32_16x16x32_bf16 v[52:55], v[32:35], v[116:119], 0
  s_waitcnt lgkmcnt(4)
  v_mfma_f32_16x16x32_bf16 v[48:51], v[36:39], v[120:123], v[48:51]
  v_mfma_f32_16x16x32_bf16 v[52:55], v[36:39], v[124:127], v[52:55]
  s_waitcnt lgkmcnt(2)
  v_mfma_f32_16x16x32_bf16 v[48:51], v[40:43], v[128:131], v[48:51]
  v_mfma_f32_16x16x32_bf16 v[52:55], v[40:43], v[132:135], v[52:55]
  s_waitcnt lgkmcnt(0)
  v_mfma_f32_16x16x32_bf16 v[48:51], v[44:47], v[136:139], v[48:51]
  v_mfma_f32_16x16x32_bf16 v[52:55], v[44:47], v[140:143], v[52:55]
  s_branch L_st_44
L_part_45:
  ds_read_b64_tr_b16 v[32:33], v21 offset:0
  ds_read_b64_tr_b16 v[34:35], v21 offset:1024
  s_waitcnt lgkmcnt(0)
  v_mfma_f32_16x16x32_bf16 v[48:51], v[32:35], v[112:115], 0
  v_mfma_f32_16x16x32_bf16 v[52:55], v[32:35], v[116:119], 0
  s_cmp_le_u32 s67, 1
  s_cbranch_scc1 L_st_44
  ds_read_b64_tr_b16 v[36:37], v21 offset:8192
  ds_read_b64_tr_b16 v[38:39], v21 offset:9216
  s_waitcnt lgkmcnt(0)
  v_mfma_f32_16x16x32_bf16 v[48:51], v[36:39], v[120:123], v[48:51]
  v_mfma_f32_16x16x32_bf16 v[52:55], v[36:39], v[124:127], v[52:55]
  s_cmp_le_u32 s67, 2
  s_cbranch_scc1 L_st_44
  ds_read_b64_tr_b16 v[40:41], v21 offset:16384
  ds_read_b64_tr_b16 v[42:43], v21 offset:17408
  s_waitcnt lgkmcnt(0)
  v_mfma_f32_16x16x32_bf16 v[48:51], v[40:43], v[128:131], v[48:51]
  v_mfma_f32_16x16x32_bf16 v[52:55], v[40:43], v[132:135], v[52:55]
L_st_44:
  s_cmp_le_u32 s51, 2
  s_cbranch_scc1 L_vw_46
  s_waitcnt vmcnt(4)
  s_branch L_vw_47
L_vw_46:
  s_waitcnt vmcnt(0)
L_vw_47:
  s_cmp_eq_u32 s23, 1
  s_cbranch_scc1 L_noml
  s_cmp_gt_u32 s18, 1
  s_cbranch_scc1 L_noml
  s_lshl_b32 s71, s2, 9
  s_lshl_b32 s72, s18, 8
  s_add_u32 s71, s71, s72
  s_add_u32 s71, s71, 8192
  s_cmp_eq_u32 s18, 0
  s_cselect_b64 vcc, -1, 0
  s_nop 3
  v_cndmask_b32 v240, v26, v24, vcc
  v_cndmask_b32 v241, v60, v56, vcc
  v_mov_b32 v242, s64
  v_mov_b32 v243, s65
  s_mov_b64 exec, 0xffff
  s_cmp_eq_u32 s100, 0
  s_cbranch_scc1 L_mlsc1
  buffer_store_dwordx4 v[240:243], v27, s[44:47], s71 offen
  s_branch L_mlok
L_mlsc1:
  buffer_store_dwordx4 v[240:243], v27, s[44:47], s71 offen sc1
L_mlok:
  s_mov_b64 exec, -1
L_noml:
  s_cmp_le_u32 s51, 3
  s_cbranch_scc1 L_vn_48
  s_add_u32 s70, s101, 98304
  s_mov_b32 m0, s70
  s_nop 0
  buffer_load_dwordx4 v8, s[28:31], s58 offen offset:0 nt lds
  buffer_load_dwordx4 v9, s[28:31], s58 offen offset:1024 nt lds
  buffer_load_dwordx4 v10, s[28:31], s58 offen offset:2048 nt lds
  buffer_load_dwordx4 v11, s[28:31], s58 offen offset:3072 nt lds
L_vn_48:
  s_cmp_le_u32 s66, 1
  s_cbranch_scc1 L_pvdone
  s_barrier
  s_cmp_lt_u32 s67, 8
  s_cbranch_scc1 L_part_50
  ds_read_b64_tr_b16 v[32:33], v21 offset:32768
  ds_read_b64_tr_b16 v[34:35], v21 offset:33792
  ds_read_b64_tr_b16 v[36:37], v21 offset:40960
  ds_read_b64_tr_b16 v[38:39], v21 offset:41984
  ds_read_b64_tr_b16 v[40:41], v21 offset:49152
  ds_read_b64_tr_b16 v[42:43], v21 offset:50176
  ds_read_b64_tr_b16 v[44:45], v21 offset:57344
  ds_read_b64_tr_b16 v[46:47], v21 offset:58368
  s_waitcnt lgkmcnt(6)
  v_mfma_f32_16x16x32_bf16 v[48:51], v[32:35], v[144:147], v[48:51]
  v_mfma_f32_16x16x32_bf16 v[52:55], v[32:35], v[148:151], v[52:55]
  s_waitcnt lgkmcnt(4)
  v_mfma_f32_16x16x32_bf16 v[48:51], v[36:39], v[152:155], v[48:51]
  v_mfma_f32_16x16x32_bf16 v[52:55], v[36:39], v[156:159], v[52:55]
  s_waitcnt lgkmcnt(2)
  v_mfma_f32_16x16x32_bf16 v[48:51], v[40:43], v[160:163], v[48:51]
  v_mfma_f32_16x16x32_bf16 v[52:55], v[40:43], v[164:167], v[52:55]
  s_waitcnt lgkmcnt(0)
  v_mfma_f32_16x16x32_bf16 v[48:51], v[44:47], v[168:171], v[48:51]
  v_mfma_f32_16x16x32_bf16 v[52:55], v[44:47], v[172:175], v[52:55]
  s_branch L_st_49
L_part_50:
  ds_read_b64_tr_b16 v[32:33], v21 offset:32768
  ds_read_b64_tr_b16 v[34:35], v21 offset:33792
  s_waitcnt lgkmcnt(0)
  v_mfma_f32_16x16x32_bf16 v[48:51], v[32:35], v[144:147], v[48:51]
  v_mfma_f32_16x16x32_bf16 v[52:55], v[32:35], v[148:151], v[52:55]
  s_cmp_le_u32 s67, 5
  s_cbranch_scc1 L_st_49
  ds_read_b64_tr_b16 v[36:37], v21 offset:40960
  ds_read_b64_tr_b16 v[38:39], v21 offset:41984
  s_waitcnt lgkmcnt(0)
  v_mfma_f32_16x16x32_bf16 v[48:51], v[36:39], v[152:155], v[48:51]
  v_mfma_f32_16x16x32_bf16 v[52:55], v[36:39], v[156:159], v[52:55]
  s_cmp_le_u32 s67, 6
  s_cbranch_scc1 L_st_49
  ds_read_b64_tr_b16 v[40:41], v21 offset:49152
  ds_read_b64_tr_b16 v[42:43], v21 offset:50176
  s_waitcnt lgkmcnt(0)
  v_mfma_f32_16x16x32_bf16 v[48:51], v[40:43], v[160:163], v[48:51]
  v_mfma_f32_16x16x32_bf16 v[52:55], v[40:43], v[164:167], v[52:55]
L_st_49:
L_stage2:
  s_cmp_le_u32 s66, 2
  s_cbranch_scc1 L_pvdone
  s_cmp_le_u32 s51, 3
  s_cbranch_scc1 L_vw_51
  s_waitcnt vmcnt(4)
  s_branch L_vw_52
L_vw_51:
  s_waitcnt vmcnt(0)
L_vw_52:
  s_barrier
  s_cmp_lg_u32 s66, 3
  s_cbranch_scc1 L_s2_53
  s_cmp_eq_u32 s3, 1
  s_cbranch_scc0 L_lw_54
  buffer_load_dwordx4 v[144:147], v255, s[44:47], s32 offen sc1
  buffer_load_dwordx4 v[148:151], v255, s[44:47], s33 offen sc1
  buffer_load_dwordx4 v[152:155], v255, s[44:47], s34 offen sc1
  buffer_load_dwordx4 v[156:159], v255, s[44:47], s35 offen sc1
  s_mov_b32 s3, 2
L_lw_54:
L_s2_53:
  s_cmp_lt_u32 s67, 12
  s_cbranch_scc1 L_part_56
  ds_read_b64_tr_b16 v[32:33], v22 offset:0
  ds_read_b64_tr_b16 v[34:35], v22 offset:1024
  ds_read_b64_tr_b16 v[36:37], v22 offset:8192
  ds_read_b64_tr_b16 v[38:39], v22 offset:9216
  ds_read_b64_tr_b16 v[40:41], v22 offset:16384
  ds_read_b64_tr_b16 v[42:43], v22 offset:17408
  ds_read_b64_tr_b16 v[44:45], v22 offset:24576
  ds_read_b64_tr_b16 v[46:47], v22 offset:25600
  s_waitcnt lgkmcnt(6)
  v_mfma_f32_16x16x32_bf16 v[48:51], v[32:35], v[176:179], v[48:51]
  v_mfma_f32_16x16x32_bf16 v[52:55], v[32:35], v[180:183], v[52:55]
  s_waitcnt lgkmcnt(4)
  v_mfma_f32_16x16x32_bf16 v[48:51], v[36:39], v[184:187], v[48:51]
  v_mfma_f32_16x16x32_bf16 v[52:55], v[36:39], v[188:191], v[52:55]
  s_waitcnt lgkmcnt(2)
  v_mfma_f32_16x16x32_bf16 v[48:51], v[40:43], v[192:195], v[48:51]
  v_mfma_f32_16x16x32_bf16 v[52:55], v[40:43], v[196:199], v[52:55]
  s_waitcnt lgkmcnt(0)
  v_mfma_f32_16x16x32_bf16 v[48:51], v[44:47], v[200:203], v[48:51]
  v_mfma_f32_16x16x32_bf16 v[52:55], v[44:47], v[204:207], v[52:55]
  s_branch L_st_55
L_part_56:
  ds_read_b64_tr_b16 v[32:33], v22 offset:0
  ds_read_b64_tr_b16 v[34:35], v22 offset:1024
  s_waitcnt lgkmcnt(0)
  v_mfma_f32_16x16x32_bf16 v[48:51], v[32:35], v[176:179], v[48:51]
  v_mfma_f32_16x16x32_bf16 v[52:55], v[32:35], v[180:183], v[52:55]
  s_cmp_le_u32 s67, 9
  s_cbranch_scc1 L_st_55
  ds_read_b64_tr_b16 v[36:37], v22 offset:8192
  ds_read_b64_tr_b16 v[38:39], v22 offset:9216
  s_waitcnt lgkmcnt(0)
  v_mfma_f32_16x16x32_bf16 v[48:51], v[36:39], v[184:187], v[48:51]
  v_mfma_f32_16x16x32_bf16 v[52:55], v[36:39], v[188:191], v[52:55]
  s_cmp_le_u32 s67, 10
  s_cbranch_scc1 L_st_55
  ds_read_b64_tr_b16 v[40:41], v22 offset:16384
  ds_read_b64_tr_b16 v[42:43], v22 offset:17408
  s_waitcnt lgkmcnt(0)
  v_mfma_f32_16x16x32_bf16 v[48:51], v[40:43], v[192:195], v[48:51]
  v_mfma_f32_16x16x32_bf16 v[52:55], v[40:43], v[196:199], v[52:55]
L_st_55:
  s_cmp_le_u32 s66, 3
  s_cbranch_scc1 L_pvdone
  s_waitcnt vmcnt(0)
  s_barrier
  s_cmp_eq_u32 s3, 1
  s_cbranch_scc0 L_lw_57
  buffer_load_dwordx4 v[144:147], v255, s[44:47], s32 offen sc1
  buffer_load_dwordx4 v[148:151], v255, s[44:47], s33 offen sc1
  buffer_load_dwordx4 v[152:155], v255, s[44:47], s34 offen sc1
  buffer_load_dwordx4 v[156:159], v255, s[44:47], s35 offen sc1
  s_mov_b32 s3, 2
L_lw_57:
  s_cmp_lt_u32 s67, 16
  s_cbranch_scc1 L_part_59
  ds_read_b64_tr_b16 v[32:33], v22 offset:32768
  ds_read_b64_tr_b16 v[34:35], v22 offset:33792
  ds_read_b64_tr_b16 v[36:37], v22 offset:40960
  ds_read_b64_tr_b16 v[38:39], v22 offset:41984
  ds_read_b64_tr_b16 v[40:41], v22 offset:49152
  ds_read_b64_tr_b16 v[42:43], v22 offset:50176
  ds_read_b64_tr_b16 v[44:45], v22 offset:57344
  ds_read_b64_tr_b16 v[46:47], v22 offset:58368
  s_waitcnt lgkmcnt(6)
  v_mfma_f32_16x16x32_bf16 v[48:51], v[32:35], v[208:211], v[48:51]
  v_mfma_f32_16x16x32_bf16 v[52:55], v[32:35], v[212:215], v[52:55]
  s_waitcnt lgkmcnt(4)
  v_mfma_f32_16x16x32_bf16 v[48:51], v[36:39], v[216:219], v[48:51]
  v_mfma_f32_16x16x32_bf16 v[52:55], v[36:39], v[220:223], v[52:55]
  s_waitcnt lgkmcnt(2)
  v_mfma_f32_16x16x32_bf16 v[48:51], v[40:43], v[224:227], v[48:51]
  v_mfma_f32_16x16x32_bf16 v[52:55], v[40:43], v[228:231], v[52:55]
  s_waitcnt lgkmcnt(0)
  v_mfma_f32_16x16x32_bf16 v[48:51], v[44:47], v[232:235], v[48:51]
  v_mfma_f32_16x16x32_bf16 v[52:55], v[44:47], v[236:239], v[52:55]
  s_branch L_st_58
L_part_59:
  ds_read_b64_tr_b16 v[32:33], v22 offset:32768
  ds_read_b64_tr_b16 v[34:35], v22 offset:33792
  s_waitcnt lgkmcnt(0)
  v_mfma_f32_16x16x32_bf16 v[48:51], v[32:35], v[208:211], v[48:51]
  v_mfma_f32_16x16x32_bf16 v[52:55], v[32:35], v[212:215], v[52:55]
  s_cmp_le_u32 s67, 13
  s_cbranch_scc1 L_st_58
  ds_read_b64_tr_b16 v[36:37], v22 offset:40960
  ds_read_b64_tr_b16 v[38:39], v22 offset:41984
  s_waitcnt lgkmcnt(0)
  v_mfma_f32_16x16x32_bf16 v[48:51], v[36:39], v[216:219], v[48:51]
  v_mfma_f32_16x16x32_bf16 v[52:55], v[36:39], v[220:223], v[52:55]
  s_cmp_le_u32 s67, 14
  s_cbranch_scc1 L_st_58
  ds_read_b64_tr_b16 v[40:41], v22 offset:49152
  ds_read_b64_tr_b16 v[42:43], v22 offset:50176
  s_waitcnt lgkmcnt(0)
  v_mfma_f32_16x16x32_bf16 v[48:51], v[40:43], v[224:227], v[48:51]
  v_mfma_f32_16x16x32_bf16 v[52:55], v[40:43], v[228:231], v[52:55]
L_st_58:
L_pvdone:
  s_cmp_ge_u32 s3, 2
  s_cbranch_scc0 L_slow
  s_cmp_eq_u32 s6, 0
  s_cbranch_scc1 L_fown0
  s_cmp_eq_u32 s6, 1
  s_cbranch_scc1 L_fown1
  s_nop 1
  v_and_or_b32 v240, v48, v75, s60
  v_and_or_b32 v241, v49, v75, s61
  v_and_or_b32 v242, v50, v75, s62
  v_and_or_b32 v243, v51, v75, s63
  buffer_store_dwordx4 v[240:243], v27, s[44:47], s4 offen
  v_and_or_b32 v244, v52, v75, s60
  v_and_or_b32 v245, v53, v75, s61
  v_and_or_b32 v246, v54, v75, s62
  v_and_or_b32 v247, v55, v75, s63
  buffer_store_dwordx4 v[244:247], v27, s[44:47], s5 offen
  s_branch L_fin
L_fown1:
  s_nop 1
  v_and_or_b32 v240, v48, v75, s60
  v_and_or_b32 v241, v49, v75, s61
  v_and_or_b32 v242, v50, v75, s62
  v_and_or_b32 v243, v51, v75, s63
  buffer_store_dwordx4 v[240:243], v27, s[44:47], s4 offen
  v_mov_b32 v248, v52
  v_mov_b32 v249, v53
  v_mov_b32 v250, v54
  v_mov_b32 v251, v55
  v_mov_b32 v252, v26
  v_mov_b32 v253, v60
  s_branch L_fdisp
L_fown0:
  s_nop 3
  v_and_or_b32 v240, v52, v75, s60
  v_and_or_b32 v241, v53, v75, s61
  v_and_or_b32 v242, v54, v75, s62
  v_and_or_b32 v243, v55, v75, s63
  buffer_store_dwordx4 v[240:243], v27, s[44:47], s5 offen
  v_mov_b32 v248, v48
  v_mov_b32 v249, v49
  v_mov_b32 v250, v50
  v_mov_b32 v251, v51
  v_mov_b32 v252, v24
  v_mov_b32 v253, v56
L_fdisp:
  s_mov_b32 s77, 0
  s_cmp_eq_u32 s23, 5
  s_cbranch_scc1 L_f5
  s_cmp_eq_u32 s23, 3
  s_cbranch_scc1 L_f3
  s_cmp_eq_u32 s23, 2
  s_cbranch_scc1 L_f2
L_f4:
  buffer_load_dwordx4 v[112:115], v27, s[44:47], s9 offen sc1
  buffer_load_dwordx4 v[116:119], v27, s[44:47], s10 offen sc1
  buffer_load_dwordx4 v[120:123], v27, s[44:47], s11 offen sc1
  s_waitcnt vmcnt(4)
  v_max_f32 v80, v252, v144
  v_xor_b32 v146, s64, v146
  v_xor_b32 v147, s65, v147
  v_max_f32 v80, v80, v148
  v_xor_b32 v150, s64, v150
  v_xor_b32 v151, s65, v151
  v_max_f32 v80, v80, v152
  v_xor_b32 v154, s64, v154
  v_xor_b32 v155, s65, v155
  v_or_b32 v88, v146, v147
  v_sub_f32 v81, v252, v80
  v_sub_f32 v144, v144, v80
  v_sub_f32 v148, v148, v80
  v_sub_f32 v152, v152, v80
  v_exp_f32 v81, v81
  v_exp_f32 v144, v144
  v_exp_f32 v148, v148
  v_exp_f32 v152, v152
  v_or3_b32 v88, v88, v150, v151
  v_or3_b32 v88, v88, v154, v155
  v_mul_f32 v82, v253, v81
  v_cmp_ne_u32 vcc, 0, v88
  v_fmac_f32 v82, v145, v144
  v_fmac_f32 v82, v149, v148
  v_fmac_f32 v82, v153, v152
  v_rcp_f32 v82, v82
  s_nop 1
  s_cbranch_vccnz L_gk4
  v_mul_f32 v81, v81, v82
  v_mul_f32 v144, v144, v82
  v_mul_f32 v148, v148, v82
  v_mul_f32 v152, v152, v82
  v_mul_f32 v84, v248, v81
  v_mul_f32 v85, v249, v81
  v_mul_f32 v86, v250, v81
  v_mul_f32 v87, v251, v81
L_fp4:
  s_waitcnt vmcnt(0)
  v_xor_b32 v112, s60, v112
  v_xor_b32 v113, s61, v113
  v_xor_b32 v114, s62, v114
  v_xor_b32 v115, s63, v115
  v_xor_b32 v116, s60, v116
  v_xor_b32 v117, s61, v117
  v_xor_b32 v118, s62, v118
  v_xor_b32 v119, s63, v119
  v_xor_b32 v120, s60, v120
  v_xor_b32 v121, s61, v121
  v_xor_b32 v122, s62, v122
  v_xor_b32 v123, s63, v123
  v_or3_b32 v88, v112, v113, v114
  v_or3_b32 v88, v88, v115, v116
  v_or3_b32 v88, v88, v117, v118
  v_or3_b32 v88, v88, v119, v120
  v_or3_b32 v88, v88, v121, v122
  v_or_b32 v88, v88, v123
  v_and_b32 v88, 0xfff, v88
  v_cmp_ne_u32 vcc, 0, v88
  s_add_u32 s77, s77, 1
  s_nop 2
  s_cbranch_vccz L_fc4
  s_cmp_lt_u32 s77, 0x40000
  s_cbranch_scc0 L_fc4
  buffer_load_dwordx4 v[112:115], v27, s[44:47], s9 offen sc1
  buffer_load_dwordx4 v[116:119], v27, s[44:47], s10 offen sc1
  buffer_load_dwordx4 v[120:123], v27, s[44:47], s11 offen sc1
  s_branch L_fp4
L_fc4:
  v_fmac_f32 v84, v112, v144
  v_fmac_f32 v85, v113, v144
  v_fmac_f32 v86, v114, v144
  v_fmac_f32 v87, v115, v144
  v_fmac_f32 v84, v116, v148
  v_fmac_f32 v85, v117, v148
  v_fmac_f32 v86, v118, v148
  v_fmac_f32 v87, v119, v148
  v_fmac_f32 v84, v120, v152
  v_fmac_f32 v85, v121, v152
  v_fmac_f32 v86, v122, v152
  v_fmac_f32 v87, v123, v152
  v_cvt_pk_bf16_f32 v248, v84, v85
  v_cvt_pk_bf16_f32 v249, v86, v87
  s_branch L_store2
L_f5:
  buffer_load_dwordx4 v[112:115], v27, s[44:47], s9 offen sc1
  buffer_load_dwordx4 v[116:119], v27, s[44:47], s10 offen sc1
  buffer_load_dwordx4 v[120:123], v27, s[44:47], s11 offen sc1
  buffer_load_dwordx4 v[124:127], v27, s[44:47], s12 offen sc1
  s_waitcnt vmcnt(5)
  v_max_f32 v80, v252, v144
  v_xor_b32 v146, s64, v146
  v_xor_b32 v147, s65, v147
  v_max_f32 v80, v80, v148
  v_xor_b32 v150, s64, v150
  v_xor_b32 v151, s65, v151
  v_max_f32 v80, v80, v152
  v_xor_b32 v154, s64, v154
  v_xor_b32 v155, s65, v155
  v_max_f32 v80, v80, v156
  v_xor_b32 v158, s64, v158
  v_xor_b32 v159, s65, v159
  v_or_b32 v88, v146, v147
  v_sub_f32 v81, v252, v80
  v_sub_f32 v144, v144, v80
  v_sub_f32 v148, v148, v80
  v_sub_f32 v152, v152, v80
  v_sub_f32 v156, v156, v80
  v_exp_f32 v81, v81
  v_exp_f32 v144, v144
  v_exp_f32 v148, v148
  v_exp_f32 v152, v152
  v_exp_f32 v156, v156
  v_or3_b32 v88, v88, v150, v151
  v_or3_b32 v88, v88, v154, v155
  v_or3_b32 v88, v88, v158, v159
  v_mul_f32 v82, v253, v81
  v_cmp_ne_u32 vcc, 0, v88
  v_fmac_f32 v82, v145, v144
  v_fmac_f32 v82, v149, v148
  v_fmac_f32 v82, v153, v152
  v_fmac_f32 v82, v157, v156
  v_rcp_f32 v82, v82
  s_nop 1
  s_cbranch_vccnz L_gk5
  v_mul_f32 v81, v81, v82
  v_mul_f32 v144, v144, v82
  v_mul_f32 v148, v148, v82
  v_mul_f32 v152, v152, v82
  v_mul_f32 v156, v156, v82
  v_mul_f32 v84, v248, v81
  v_mul_f32 v85, v249, v81
  v_mul_f32 v86, v250, v81
  v_mul_f32 v87, v251, v81
L_fp5:
  s_waitcnt vmcnt(0)
  v_xor_b32 v112, s60, v112
  v_xor_b32 v113, s61, v113
  v_xor_b32 v114, s62, v114
  v_xor_b32 v115, s63, v115
  v_xor_b32 v116, s60, v116
  v_xor_b32 v117, s61, v117
  v_xor_b32 v118, s62, v118
  v_xor_b32 v119, s63, v119
  v_xor_b32 v120, s60, v120
  v_xor_b32 v121, s61, v121
  v_xor_b32 v122, s62, v122
  v_xor_b32 v123, s63, v123
  v_xor_b32 v124, s60, v124
  v_xor_b32 v125, s61, v125
  v_xor_b32 v126, s62, v126
  v_xor_b32 v127, s63, v127
  v_or3_b32 v88, v112, v113, v114
  v_or3_b32 v88, v88, v115, v116
  v_or3_b32 v88, v88, v117, v118
  v_or3_b32 v88, v88, v119, v120
  v_or3_b32 v88, v88, v121, v122
  v_or3_b32 v88, v88, v123, v124
  v_or3_b32 v88, v88, v125, v126
  v_or_b32 v88, v88, v127
  v_and_b32 v88, 0xfff, v88
  v_cmp_ne_u32 vcc, 0, v88
  s_add_u32 s77, s77, 1
  s_nop 2
  s_cbranch_vccz L_fc5
  s_cmp_lt_u32 s77, 0x40000
  s_cbranch_scc0 L_fc5
  buffer_load_dwordx4 v[112:115], v27, s[44:47], s9 offen sc1
  buffer_load_dwordx4 v[116:119], v27, s[44:47], s10 offen sc1
  buffer_load_dwordx4 v[120:123], v27, s[44:47], s11 offen sc1
  buffer_load_dwordx4 v[124:127], v27, s[44:47], s12 offen sc1
  s_branch L_fp5
L_fc5:
  v_fmac_f32 v84, v112, v144
  v_fmac_f32 v85, v113, v144
  v_fmac_f32 v86, v114, v144
  v_fmac_f32 v87, v115, v144
  v_fmac_f32 v84, v116, v148
  v_fmac_f32 v85, v117, v148
  v_fmac_f32 v86, v118, v148
  v_fmac_f32 v87, v119, v148
  v_fmac_f32 v84, v120, v152
  v_fmac_f32 v85, v121, v152
  v_fmac_f32 v86, v122, v152
  v_fmac_f32 v87, v123, v152
  v_fmac_f32 v84, v124, v156
  v_fmac_f32 v85, v125, v156
  v_fmac_f32 v86, v126, v156
  v_fmac_f32 v87, v127, v156
  v_cvt_pk_bf16_f32 v248, v84, v85
  v_cvt_pk_bf16_f32 v249, v86, v87
  s_branch L_store2
L_f3:
  buffer_load_dwordx4 v[112:115], v27, s[44:47], s9 offen sc1
  buffer_load_dwordx4 v[116:119], v27, s[44:47], s10 offen sc1
  s_waitcnt vmcnt(3)
  v_max_f32 v80, v252, v144
  v_xor_b32 v146, s64, v146
  v_xor_b32 v147, s65, v147
  v_max_f32 v80, v80, v148
  v_xor_b32 v150, s64, v150
  v_xor_b32 v151, s65, v151
  v_or_b32 v88, v146, v147
  v_sub_f32 v81, v252, v80
  v_sub_f32 v144, v144, v80
  v_sub_f32 v148, v148, v80
  v_exp_f32 v81, v81
  v_exp_f32 v144, v144
  v_exp_f32 v148, v148
  v_or3_b32 v88, v88, v150, v151
  v_mul_f32 v82, v253, v81
  v_cmp_ne_u32 vcc, 0, v88
  v_fmac_f32 v82, v145, v144
  v_fmac_f32 v82, v149, v148
  v_rcp_f32 v82, v82
  s_nop 1
  s_cbranch_vccnz L_gk3
  v_mul_f32 v81, v81, v82
  v_mul_f32 v144, v144, v82
  v_mul_f32 v148, v148, v82
  v_mul_f32 v84, v248, v81
  v_mul_f32 v85, v249, v81
  v_mul_f32 v86, v250, v81
  v_mul_f32 v87, v251, v81
L_fp3:
  s_waitcnt vmcnt(0)
  v_xor_b32 v112, s60, v112
  v_xor_b32 v113, s61, v113
  v_xor_b32 v114, s62, v114
  v_xor_b32 v115, s63, v115
  v_xor_b32 v116, s60, v116
  v_xor_b32 v117, s61, v117
  v_xor_b32 v118, s62, v118
  v_xor_b32 v119, s63, v119
  v_or3_b32 v88, v112, v113, v114
  v_or3_b32 v88, v88, v115, v116
  v_or3_b32 v88, v88, v117, v118
  v_or_b32 v88, v88, v119
  v_and_b32 v88, 0xfff, v88
  v_cmp_ne_u32 vcc, 0, v88
  s_add_u32 s77, s77, 1
  s_nop 2
  s_cbranch_vccz L_fc3
  s_cmp_lt_u32 s77, 0x40000
  s_cbranch_scc0 L_fc3
  buffer_load_dwordx4 v[112:115], v27, s[44:47], s9 offen sc1
  buffer_load_dwordx4 v[116:119], v27, s[44:47], s10 offen sc1
  s_branch L_fp3
L_fc3:
  v_fmac_f32 v84, v112, v144
  v_fmac_f32 v85, v113, v144
  v_fmac_f32 v86, v114, v144
  v_fmac_f32 v87, v115, v144
  v_fmac_f32 v84, v116, v148
  v_fmac_f32 v85, v117, v148
  v_fmac_f32 v86, v118, v148
  v_fmac_f32 v87, v119, v148
  v_cvt_pk_bf16_f32 v248, v84, v85
  v_cvt_pk_bf16_f32 v249, v86, v87
  s_branch L_store2
L_f2:
  buffer_load_dwordx4 v[112:115], v27, s[44:47], s9 offen sc1
  s_waitcnt vmcnt(2)
  v_max_f32 v80, v252, v144
  v_xor_b32 v146, s64, v146
  v_xor_b32 v147, s65, v147
  v_or_b32 v88, v146, v147
  v_sub_f32 v81, v252, v80
  v_sub_f32 v144, v144, v80
  v_exp_f32 v81, v81
  v_exp_f32 v144, v144
  v_mul_f32 v82, v253, v81
  v_cmp_ne_u32 vcc, 0, v88
  v_fmac_f32 v82, v145, v144
  v_rcp_f32 v82, v82
  s_nop 1
  s_cbranch_vccnz L_gk2
  v_mul_f32 v81, v81, v82
  v_mul_f32 v144, v144, v82
  v_mul_f32 v84, v248, v81
  v_mul_f32 v85, v249, v81
  v_mul_f32 v86, v250, v81
  v_mul_f32 v87, v251, v81
L_fp2:
  s_waitcnt vmcnt(0)
  v_xor_b32 v112, s60, v112
  v_xor_b32 v113, s61, v113
  v_xor_b32 v114, s62, v114
  v_xor_b32 v115, s63, v115
  v_or3_b32 v88, v112, v113, v114
  v_or_b32 v88, v88, v115
  v_and_b32 v88, 0xfff, v88
  v_cmp_ne_u32 vcc, 0, v88
  s_add_u32 s77, s77, 1
  s_nop 2
  s_cbranch_vccz L_fc2
  s_cmp_lt_u32 s77, 0x40000
  s_cbranch_scc0 L_fc2
  buffer_load_dwordx4 v[112:115], v27, s[44:47], s9 offen sc1
  s_branch L_fp2
L_fc2:
  v_fmac_f32 v84, v112, v144
  v_fmac_f32 v85, v113, v144
  v_fmac_f32 v86, v114, v144
  v_fmac_f32 v87, v115, v144
  v_cvt_pk_bf16_f32 v248, v84, v85
  v_cvt_pk_bf16_f32 v249, v86, v87
L_store2:
  buffer_store_dwordx2 v[248:249], v254, s[40:43], 0 offen
  s_or_b32 s70, s22, s18
  s_cbranch_scc1 L_fin
  s_lshl_b32 s70, s19, 5
  s_lshl_b32 s71, s21, 2
  s_add_u32 s70, s70, s71
  s_add_u32 s71, s53, 1
  v_mov_b32 v240, s71
  v_mov_b32 v241, 0
  s_mov_b64 exec, 1
  buffer_store_dword v240, v241, s[44:47], s70 offen sc1
  s_mov_b64 exec, -1
L_fin:
L_end:
  s_endpgm
L_slow:
  s_cmp_eq_u32 s23, 1
  s_cbranch_scc1 L_single
  s_nop 3
  s_cmp_eq_u32 s7, s22
  s_cbranch_scc1 L_nopub_60
  v_and_b32 v240, 0xfffff000, v48
  v_and_b32 v241, 0xfffff000, v49
  v_and_b32 v242, 0xfffff000, v50
  v_and_b32 v243, 0xfffff000, v51
  v_or_b32 v240, s60, v240
  v_or_b32 v241, s61, v241
  v_or_b32 v242, s62, v242
  v_or_b32 v243, s63, v243
  s_cmp_eq_u32 s100, 0
  s_cbranch_scc1 L_pubsc1_61
  buffer_store_dwordx4 v[240:243], v27, s[44:47], s4 offen
  s_branch L_nopub_60
L_pubsc1_61:
  buffer_store_dwordx4 v[240:243], v27, s[44:47], s4 offen sc1
L_nopub_60:
  s_cmp_eq_u32 s8, s22
  s_cbranch_scc1 L_nopub_62
  v_and_b32 v244, 0xfffff000, v52
  v_and_b32 v245, 0xfffff000, v53
  v_and_b32 v246, 0xfffff000, v54
  v_and_b32 v247, 0xfffff000, v55
  v_or_b32 v244, s60, v244
  v_or_b32 v245, s61, v245
  v_or_b32 v246, s62, v246
  v_or_b32 v247, s63, v247
  s_cmp_eq_u32 s100, 0
  s_cbranch_scc1 L_pubsc1_63
  buffer_store_dwordx4 v[244:247], v27, s[44:47], s5 offen
  s_branch L_nopub_62
L_pubsc1_63:
  buffer_store_dwordx4 v[244:247], v27, s[44:47], s5 offen sc1
L_nopub_62:
  s_cmp_eq_u32 s6, 2
  s_cbranch_scc1 L_fin
  s_cmp_eq_u32 s6, 0
  s_cselect_b64 vcc, -1, 0
  s_mov_b32 s77, 0
  s_nop 2
  v_cndmask_b32 v248, v52, v48, vcc
  v_cndmask_b32 v249, v53, v49, vcc
  v_cndmask_b32 v250, v54, v50, vcc
  v_cndmask_b32 v251, v55, v51, vcc
  v_cndmask_b32 v252, v26, v24, vcc
  v_cndmask_b32 v253, v60, v56, vcc
  s_cmp_eq_u32 s23, 2
  s_cbranch_scc1 L_gk2
  s_cmp_eq_u32 s23, 3
  s_cbranch_scc1 L_gk3
  s_cmp_eq_u32 s23, 4
  s_cbranch_scc1 L_gk4
  s_cmp_eq_u32 s23, 5
  s_cbranch_scc1 L_gk5
  s_cmp_eq_u32 s23, 6
  s_cbranch_scc1 L_gk6
  s_cmp_eq_u32 s23, 7
  s_cbranch_scc1 L_gk7
  s_cmp_eq_u32 s23, 8
  s_cbranch_scc1 L_gk8
  s_branch L_fin
L_gk2:
  buffer_load_dwordx4 v[144:147], v255, s[44:47], s32 offen sc1
  buffer_load_dwordx4 v[112:115], v27, s[44:47], s9 offen sc1
L_ck2:
  s_waitcnt vmcnt(0)
  v_xor_b32 v112, s60, v112
  v_xor_b32 v113, s61, v113
  v_xor_b32 v114, s62, v114
  v_xor_b32 v115, s63, v115
  v_xor_b32 v146, s64, v146
  v_xor_b32 v147, s65, v147
  v_or3_b32 v246, v112, v113, v114
  v_or_b32 v246, v246, v115
  v_or_b32 v247, v146, v147
  v_and_b32 v246, 0xfff, v246
  v_or_b32 v246, v246, v247
  v_cmp_ne_u32 vcc, 0, v246
  s_add_u32 s77, s77, 1
  s_nop 2
  s_cbranch_vccz L_c2
  s_cmp_lt_u32 s77, 0x40000
  s_cbranch_scc1 L_gk2
L_c2:
  v_max_f32 v246, v252, v144
  v_sub_f32 v252, v252, v246
  v_sub_f32 v144, v144, v246
  v_exp_f32 v252, v252
  v_exp_f32 v144, v144
  s_nop 0
  v_mul_f32 v253, v253, v252
  v_fmac_f32 v253, v145, v144
  v_rcp_f32 v253, v253
  v_mul_f32 v248, v248, v252
  v_mul_f32 v249, v249, v252
  v_mul_f32 v250, v250, v252
  v_mul_f32 v251, v251, v252
  v_fmac_f32 v248, v112, v144
  v_fmac_f32 v249, v113, v144
  v_fmac_f32 v250, v114, v144
  v_fmac_f32 v251, v115, v144
  s_branch L_store1
L_gk3:
  buffer_load_dwordx4 v[144:147], v255, s[44:47], s32 offen sc1
  buffer_load_dwordx4 v[148:151], v255, s[44:47], s33 offen sc1
  buffer_load_dwordx4 v[112:115], v27, s[44:47], s9 offen sc1
  buffer_load_dwordx4 v[116:119], v27, s[44:47], s10 offen sc1
L_ck3:
  s_waitcnt vmcnt(0)
  v_xor_b32 v112, s60, v112
  v_xor_b32 v113, s61, v113
  v_xor_b32 v114, s62, v114
  v_xor_b32 v115, s63, v115
  v_xor_b32 v146, s64, v146
  v_xor_b32 v147, s65, v147
  v_or3_b32 v246, v112, v113, v114
  v_or_b32 v246, v246, v115
  v_or_b32 v247, v146, v147
  v_xor_b32 v116, s60, v116
  v_xor_b32 v117, s61, v117
  v_xor_b32 v118, s62, v118
  v_xor_b32 v119, s63, v119
  v_xor_b32 v150, s64, v150
  v_xor_b32 v151, s65, v151
  v_or3_b32 v246, v246, v116, v117
  v_or3_b32 v246, v246, v118, v119
  v_or3_b32 v247, v247, v150, v151
  v_and_b32 v246, 0xfff, v246
  v_or_b32 v246, v246, v247
  v_cmp_ne_u32 vcc, 0, v246
  s_add_u32 s77, s77, 1
  s_nop 2
  s_cbranch_vccz L_c3
  s_cmp_lt_u32 s77, 0x40000
  s_cbranch_scc1 L_gk3
L_c3:
  v_max_f32 v246, v252, v144
  v_max_f32 v246, v246, v148
  v_sub_f32 v252, v252, v246
  v_sub_f32 v144, v144, v246
  v_sub_f32 v148, v148, v246
  v_exp_f32 v252, v252
  v_exp_f32 v144, v144
  v_exp_f32 v148, v148
  s_nop 0
  v_mul_f32 v253, v253, v252
  v_fmac_f32 v253, v145, v144
  v_fmac_f32 v253, v149, v148
  v_rcp_f32 v253, v253
  v_mul_f32 v248, v248, v252
  v_mul_f32 v249, v249, v252
  v_mul_f32 v250, v250, v252
  v_mul_f32 v251, v251, v252
  v_fmac_f32 v248, v112, v144
  v_fmac_f32 v249, v113, v144
  v_fmac_f32 v250, v114, v144
  v_fmac_f32 v251, v115, v144
  v_fmac_f32 v248, v116, v148
  v_fmac_f32 v249, v117, v148
  v_fmac_f32 v250, v118, v148
  v_fmac_f32 v251, v119, v148
  s_branch L_store1
L_gk4:
  buffer_load_dwordx4 v[144:147], v255, s[44:47], s32 offen sc1
  buffer_load_dwordx4 v[148:151], v255, s[44:47], s33 offen sc1
  buffer_load_dwordx4 v[152:155], v255, s[44:47], s34 offen sc1
  buffer_load_dwordx4 v[112:115], v27, s[44:47], s9 offen sc1
  buffer_load_dwordx4 v[116:119], v27, s[44:47], s10 offen sc1
  buffer_load_dwordx4 v[120:123], v27, s[44:47], s11 offen sc1
L_ck4:
  s_waitcnt vmcnt(0)
  v_xor_b32 v112, s60, v112
  v_xor_b32 v113, s61, v113
  v_xor_b32 v114, s62, v114
  v_xor_b32 v115, s63, v115
  v_xor_b32 v146, s64, v146
  v_xor_b32 v147, s65, v147
  v_or3_b32 v246, v112, v113, v114
  v_or_b32 v246, v246, v115
  v_or_b32 v247, v146, v147
  v_xor_b32 v116, s60, v116
  v_xor_b32 v117, s61, v117
  v_xor_b32 v118, s62, v118
  v_xor_b32 v119, s63, v119
  v_xor_b32 v150, s64, v150
  v_xor_b32 v151, s65, v151
  v_or3_b32 v246, v246, v116, v117
  v_or3_b32 v246, v246, v118, v119
  v_or3_b32 v247, v247, v150, v151
  v_xor_b32 v120, s60, v120
  v_xor_b32 v121, s61, v121
  v_xor_b32 v122, s62, v122
  v_xor_b32 v123, s63, v123
  v_xor_b32 v154, s64, v154
  v_xor_b32 v155, s65, v155
  v_or3_b32 v246, v246, v120, v121
  v_or3_b32 v246, v246, v122, v123
  v_or3_b32 v247, v247, v154, v155
  v_and_b32 v246, 0xfff, v246
  v_or_b32 v246, v246, v247
  v_cmp_ne_u32 vcc, 0, v246
  s_add_u32 s77, s77, 1
  s_nop 2
  s_cbranch_vccz L_c4
  s_cmp_lt_u32 s77, 0x40000
  s_cbranch_scc1 L_gk4
L_c4:
  v_max_f32 v246, v252, v144
  v_max_f32 v246, v246, v148
  v_max_f32 v246, v246, v152
  v_sub_f32 v252, v252, v246
  v_sub_f32 v144, v144, v246
  v_sub_f32 v148, v148, v246
  v_sub_f32 v152, v152, v246
  v_exp_f32 v252, v252
  v_exp_f32 v144, v144
  v_exp_f32 v148, v148
  v_exp_f32 v152, v152
  s_nop 0
  v_mul_f32 v253, v253, v252
  v_fmac_f32 v253, v145, v144
  v_fmac_f32 v253, v149, v148
  v_fmac_f32 v253, v153, v152
  v_rcp_f32 v253, v253
  v_mul_f32 v248, v248, v252
  v_mul_f32 v249, v249, v252
  v_mul_f32 v250, v250, v252
  v_mul_f32 v251, v251, v252
  v_fmac_f32 v248, v112, v144
  v_fmac_f32 v249, v113, v144
  v_fmac_f32 v250, v114, v144
  v_fmac_f32 v251, v115, v144
  v_fmac_f32 v248, v116, v148
  v_fmac_f32 v249, v117, v148
  v_fmac_f32 v250, v118, v148
  v_fmac_f32 v251, v119, v148
  v_fmac_f32 v248, v120, v152
  v_fmac_f32 v249, v121, v152
  v_fmac_f32 v250, v122, v152
  v_fmac_f32 v251, v123, v152
  s_branch L_store1
L_gk5:
  buffer_load_dwordx4 v[144:147], v255, s[44:47], s32 offen sc1
  buffer_load_dwordx4 v[148:151], v255, s[44:47], s33 offen sc1
  buffer_load_dwordx4 v[152:155], v255, s[44:47], s34 offen sc1
  buffer_load_dwordx4 v[156:159], v255, s[44:47], s35 offen sc1
  buffer_load_dwordx4 v[112:115], v27, s[44:47], s9 offen sc1
  buffer_load_dwordx4 v[116:119], v27, s[44:47], s10 offen sc1
  buffer_load_dwordx4 v[120:123], v27, s[44:47], s11 offen sc1
  buffer_load_dwordx4 v[124:127], v27, s[44:47], s12 offen sc1
L_ck5:
  s_waitcnt vmcnt(0)
  v_xor_b32 v112, s60, v112
  v_xor_b32 v113, s61, v113
  v_xor_b32 v114, s62, v114
  v_xor_b32 v115, s63, v115
  v_xor_b32 v146, s64, v146
  v_xor_b32 v147, s65, v147
  v_or3_b32 v246, v112, v113, v114
  v_or_b32 v246, v246, v115
  v_or_b32 v247, v146, v147
  v_xor_b32 v116, s60, v116
  v_xor_b32 v117, s61, v117
  v_xor_b32 v118, s62, v118
  v_xor_b32 v119, s63, v119
  v_xor_b32 v150, s64, v150
  v_xor_b32 v151, s65, v151
  v_or3_b32 v246, v246, v116, v117
  v_or3_b32 v246, v246, v118, v119
  v_or3_b32 v247, v247, v150, v151
  v_xor_b32 v120, s60, v120
  v_xor_b32 v121, s61, v121
  v_xor_b32 v122, s62, v122
  v_xor_b32 v123, s63, v123
  v_xor_b32 v154, s64, v154
  v_xor_b32 v155, s65, v155
  v_or3_b32 v246, v246, v120, v121
  v_or3_b32 v246, v246, v122, v123
  v_or3_b32 v247, v247, v154, v155
  v_xor_b32 v124, s60, v124
  v_xor_b32 v125, s61, v125
  v_xor_b32 v126, s62, v126
  v_xor_b32 v127, s63, v127
  v_xor_b32 v158, s64, v158
  v_xor_b32 v159, s65, v159
  v_or3_b32 v246, v246, v124, v125
  v_or3_b32 v246, v246, v126, v127
  v_or3_b32 v247, v247, v158, v159
  v_and_b32 v246, 0xfff, v246
  v_or_b32 v246, v246, v247
  v_cmp_ne_u32 vcc, 0, v246
  s_add_u32 s77, s77, 1
  s_nop 2
  s_cbranch_vccz L_c5
  s_cmp_lt_u32 s77, 0x40000
  s_cbranch_scc1 L_gk5
L_c5:
  v_max_f32 v246, v252, v144
  v_max_f32 v246, v246, v148
  v_max_f32 v246, v246, v152
  v_max_f32 v246, v246, v156
  v_sub_f32 v252, v252, v246
  v_sub_f32 v144, v144, v246
  v_sub_f32 v148, v148, v246
  v_sub_f32 v152, v152, v246
  v_sub_f32 v156, v156, v246
  v_exp_f32 v252, v252
  v_exp_f32 v144, v144
  v_exp_f32 v148, v148
  v_exp_f32 v152, v152
  v_exp_f32 v156, v156
  s_nop 0
  v_mul_f32 v253, v253, v252
  v_fmac_f32 v253, v145, v144
  v_fmac_f32 v253, v149, v148
  v_fmac_f32 v253, v153, v152
  v_fmac_f32 v253, v157, v156
  v_rcp_f32 v253, v253
  v_mul_f32 v248, v248, v252
  v_mul_f32 v249, v249, v252
  v_mul_f32 v250, v250, v252
  v_mul_f32 v251, v251, v252
  v_fmac_f32 v248, v112, v144
  v_fmac_f32 v249, v113, v144
  v_fmac_f32 v250, v114, v144
  v_fmac_f32 v251, v115, v144
  v_fmac_f32 v248, v116, v148
  v_fmac_f32 v249, v117, v148
  v_fmac_f32 v250, v118, v148
  v_fmac_f32 v251, v119, v148
  v_fmac_f32 v248, v120, v152
  v_fmac_f32 v249, v121, v152
  v_fmac_f32 v250, v122, v152
  v_fmac_f32 v251, v123, v152
  v_fmac_f32 v248, v124, v156
  v_fmac_f32 v249, v125, v156
  v_fmac_f32 v250, v126, v156
  v_fmac_f32 v251, v127, v156
  s_branch L_store1
L_gk6:
  buffer_load_dwordx4 v[144:147], v255, s[44:47], s32 offen sc1
  buffer_load_dwordx4 v[148:151], v255, s[44:47], s33 offen sc1
  buffer_load_dwordx4 v[152:155], v255, s[44:47], s34 offen sc1
  buffer_load_dwordx4 v[156:159], v255, s[44:47], s35 offen sc1
  buffer_load_dwordx4 v[160:163], v255, s[44:47], s36 offen sc1
  buffer_load_dwordx4 v[112:115], v27, s[44:47], s9 offen sc1
  buffer_load_dwordx4 v[116:119], v27, s[44:47], s10 offen sc1
  buffer_load_dwordx4 v[120:123], v27, s[44:47], s11 offen sc1
  buffer_load_dwordx4 v[124:127], v27, s[44:47], s12 offen sc1
  buffer_load_dwordx4 v[128:131], v27, s[44:47], s13 offen sc1
L_ck6:
  s_waitcnt vmcnt(0)
  v_xor_b32 v112, s60, v112
  v_xor_b32 v113, s61, v113
  v_xor_b32 v114, s62, v114
  v_xor_b32 v115, s63, v115
  v_xor_b32 v146, s64, v146
  v_xor_b32 v147, s65, v147
  v_or3_b32 v246, v112, v113, v114
  v_or_b32 v246, v246, v115
  v_or_b32 v247, v146, v147
  v_xor_b32 v116, s60, v116
  v_xor_b32 v117, s61, v117
  v_xor_b32 v118, s62, v118
  v_xor_b32 v119, s63, v119
  v_xor_b32 v150, s64, v150
  v_xor_b32 v151, s65, v151
  v_or3_b32 v246, v246, v116, v117
  v_or3_b32 v246, v246, v118, v119
  v_or3_b32 v247, v247, v150, v151
  v_xor_b32 v120, s60, v120
  v_xor_b32 v121, s61, v121
  v_xor_b32 v122, s62, v122
  v_xor_b32 v123, s63, v123
  v_xor_b32 v154, s64, v154
  v_xor_b32 v155, s65, v155
  v_or3_b32 v246, v246, v120, v121
  v_or3_b32 v246, v246, v122, v123
  v_or3_b32 v247, v247, v154, v155
  v_xor_b32 v124, s60, v124
  v_xor_b32 v125, s61, v125
  v_xor_b32 v126, s62, v126
  v_xor_b32 v127, s63, v127
  v_xor_b32 v158, s64, v158
  v_xor_b32 v159, s65, v159
  v_or3_b32 v246, v246, v124, v125
  v_or3_b32 v246, v246, v126, v127
  v_or3_b32 v247, v247, v158, v159
  v_xor_b32 v128, s60, v128
  v_xor_b32 v129, s61, v129
  v_xor_b32 v130, s62, v130
  v_xor_b32 v131, s63, v131
  v_xor_b32 v162, s64, v162
  v_xor_b32 v163, s65, v163
  v_or3_b32 v246, v246, v128, v129
  v_or3_b32 v246, v246, v130, v131
  v_or3_b32 v247, v247, v162, v163
  v_and_b32 v246, 0xfff, v246
  v_or_b32 v246, v246, v247
  v_cmp_ne_u32 vcc, 0, v246
  s_add_u32 s77, s77, 1
  s_nop 2
  s_cbranch_vccz L_c6
  s_cmp_lt_u32 s77, 0x40000
  s_cbranch_scc1 L_gk6
L_c6:
  v_max_f32 v246, v252, v144
  v_max_f32 v246, v246, v148
  v_max_f32 v246, v246, v152
  v_max_f32 v246, v246, v156
  v_max_f32 v246, v246, v160
  v_sub_f32 v252, v252, v246
  v_sub_f32 v144, v144, v246
  v_sub_f32 v148, v148, v246
  v_sub_f32 v152, v152, v246
  v_sub_f32 v156, v156, v246
  v_sub_f32 v160, v160, v246
  v_exp_f32 v252, v252
  v_exp_f32 v144, v144
  v_exp_f32 v148, v148
  v_exp_f32 v152, v152
  v_exp_f32 v156, v156
  v_exp_f32 v160, v160
  s_nop 0
  v_mul_f32 v253, v253, v252
  v_fmac_f32 v253, v145, v144
  v_fmac_f32 v253, v149, v148
  v_fmac_f32 v253, v153, v152
  v_fmac_f32 v253, v157, v156
  v_fmac_f32 v253, v161, v160
  v_rcp_f32 v253, v253
  v_mul_f32 v248, v248, v252
  v_mul_f32 v249, v249, v252
  v_mul_f32 v250, v250, v252
  v_mul_f32 v251, v251, v252
  v_fmac_f32 v248, v112, v144
  v_fmac_f32 v249, v113, v144
  v_fmac_f32 v250, v114, v144
  v_fmac_f32 v251, v115, v144
  v_fmac_f32 v248, v116, v148
  v_fmac_f32 v249, v117, v148
  v_fmac_f32 v250, v118, v148
  v_fmac_f32 v251, v119, v148
  v_fmac_f32 v248, v120, v152
  v_fmac_f32 v249, v121, v152
  v_fmac_f32 v250, v122, v152
  v_fmac_f32 v251, v123, v152
  v_fmac_f32 v248, v124, v156
  v_fmac_f32 v249, v125, v156
  v_fmac_f32 v250, v126, v156
  v_fmac_f32 v251, v127, v156
  v_fmac_f32 v248, v128, v160
  v_fmac_f32 v249, v129, v160
  v_fmac_f32 v250, v130, v160
  v_fmac_f32 v251, v131, v160
  s_branch L_store1
L_gk7:
  buffer_load_dwordx4 v[144:147], v255, s[44:47], s32 offen sc1
  buffer_load_dwordx4 v[148:151], v255, s[44:47], s33 offen sc1
  buffer_load_dwordx4 v[152:155], v255, s[44:47], s34 offen sc1
  buffer_load_dwordx4 v[156:159], v255, s[44:47], s35 offen sc1
  buffer_load_dwordx4 v[160:163], v255, s[44:47], s36 offen sc1
  buffer_load_dwordx4 v[164:167], v255, s[44:47], s37 offen sc1
  buffer_load_dwordx4 v[112:115], v27, s[44:47], s9 offen sc1
  buffer_load_dwordx4 v[116:119], v27, s[44:47], s10 offen sc1
  buffer_load_dwordx4 v[120:123], v27, s[44:47], s11 offen sc1
  buffer_load_dwordx4 v[124:127], v27, s[44:47], s12 offen sc1
  buffer_load_dwordx4 v[128:131], v27, s[44:47], s13 offen sc1
  buffer_load_dwordx4 v[132:135], v27, s[44:47], s14 offen sc1
L_ck7:
  s_waitcnt vmcnt(0)
  v_xor_b32 v112, s60, v112
  v_xor_b32 v113, s61, v113
  v_xor_b32 v114, s62, v114
  v_xor_b32 v115, s63, v115
  v_xor_b32 v146, s64, v146
  v_xor_b32 v147, s65, v147
  v_or3_b32 v246, v112, v113, v114
  v_or_b32 v246, v246, v115
  v_or_b32 v247, v146, v147
  v_xor_b32 v116, s60, v116
  v_xor_b32 v117, s61, v117
  v_xor_b32 v118, s62, v118
  v_xor_b32 v119, s63, v119
  v_xor_b32 v150, s64, v150
  v_xor_b32 v151, s65, v151
  v_or3_b32 v246, v246, v116, v117
  v_or3_b32 v246, v246, v118, v119
  v_or3_b32 v247, v247, v150, v151
  v_xor_b32 v120, s60, v120
  v_xor_b32 v121, s61, v121
  v_xor_b32 v122, s62, v122
  v_xor_b32 v123, s63, v123
  v_xor_b32 v154, s64, v154
  v_xor_b32 v155, s65, v155
  v_or3_b32 v246, v246, v120, v121
  v_or3_b32 v246, v246, v122, v123
  v_or3_b32 v247, v247, v154, v155
  v_xor_b32 v124, s60, v124
  v_xor_b32 v125, s61, v125
  v_xor_b32 v126, s62, v126
  v_xor_b32 v127, s63, v127
  v_xor_b32 v158, s64, v158
  v_xor_b32 v159, s65, v159
  v_or3_b32 v246, v246, v124, v125
  v_or3_b32 v246, v246, v126, v127
  v_or3_b32 v247, v247, v158, v159
  v_xor_b32 v128, s60, v128
  v_xor_b32 v129, s61, v129
  v_xor_b32 v130, s62, v130
  v_xor_b32 v131, s63, v131
  v_xor_b32 v162, s64, v162
  v_xor_b32 v163, s65, v163
  v_or3_b32 v246, v246, v128, v129
  v_or3_b32 v246, v246, v130, v131
  v_or3_b32 v247, v247, v162, v163
  v_xor_b32 v132, s60, v132
  v_xor_b32 v133, s61, v133
  v_xor_b32 v134, s62, v134
  v_xor_b32 v135, s63, v135
  v_xor_b32 v166, s64, v166
  v_xor_b32 v167, s65, v167
  v_or3_b32 v246, v246, v132, v133
  v_or3_b32 v246, v246, v134, v135
  v_or3_b32 v247, v247, v166, v167
  v_and_b32 v246, 0xfff, v246
  v_or_b32 v246, v246, v247
  v_cmp_ne_u32 vcc, 0, v246
  s_add_u32 s77, s77, 1
  s_nop 2
  s_cbranch_vccz L_c7
  s_cmp_lt_u32 s77, 0x40000
  s_cbranch_scc1 L_gk7
L_c7:
  v_max_f32 v246, v252, v144
  v_max_f32 v246, v246, v148
  v_max_f32 v246, v246, v152
  v_max_f32 v246, v246, v156
  v_max_f32 v246, v246, v160
  v_max_f32 v246, v246, v164
  v_sub_f32 v252, v252, v246
  v_sub_f32 v144, v144, v246
  v_sub_f32 v148, v148, v246
  v_sub_f32 v152, v152, v246
  v_sub_f32 v156, v156, v246
  v_sub_f32 v160, v160, v246
  v_sub_f32 v164, v164, v246
  v_exp_f32 v252, v252
  v_exp_f32 v144, v144
  v_exp_f32 v148, v148
  v_exp_f32 v152, v152
  v_exp_f32 v156, v156
  v_exp_f32 v160, v160
  v_exp_f32 v164, v164
  s_nop 0
  v_mul_f32 v253, v253, v252
  v_fmac_f32 v253, v145, v144
  v_fmac_f32 v253, v149, v148
  v_fmac_f32 v253, v153, v152
  v_fmac_f32 v253, v157, v156
  v_fmac_f32 v253, v161, v160
  v_fmac_f32 v253, v165, v164
  v_rcp_f32 v253, v253
  v_mul_f32 v248, v248, v252
  v_mul_f32 v249, v249, v252
  v_mul_f32 v250, v250, v252
  v_mul_f32 v251, v251, v252
  v_fmac_f32 v248, v112, v144
  v_fmac_f32 v249, v113, v144
  v_fmac_f32 v250, v114, v144
  v_fmac_f32 v251, v115, v144
  v_fmac_f32 v248, v116, v148
  v_fmac_f32 v249, v117, v148
  v_fmac_f32 v250, v118, v148
  v_fmac_f32 v251, v119, v148
  v_fmac_f32 v248, v120, v152
  v_fmac_f32 v249, v121, v152
  v_fmac_f32 v250, v122, v152
  v_fmac_f32 v251, v123, v152
  v_fmac_f32 v248, v124, v156
  v_fmac_f32 v249, v125, v156
  v_fmac_f32 v250, v126, v156
  v_fmac_f32 v251, v127, v156
  v_fmac_f32 v248, v128, v160
  v_fmac_f32 v249, v129, v160
  v_fmac_f32 v250, v130, v160
  v_fmac_f32 v251, v131, v160
  v_fmac_f32 v248, v132, v164
  v_fmac_f32 v249, v133, v164
  v_fmac_f32 v250, v134, v164
  v_fmac_f32 v251, v135, v164
  s_branch L_store1
L_gk8:
  buffer_load_dwordx4 v[144:147], v255, s[44:47], s32 offen sc1
  buffer_load_dwordx4 v[148:151], v255, s[44:47], s33 offen sc1
  buffer_load_dwordx4 v[152:155], v255, s[44:47], s34 offen sc1
  buffer_load_dwordx4 v[156:159], v255, s[44:47], s35 offen sc1
  buffer_load_dwordx4 v[160:163], v255, s[44:47], s36 offen sc1
  buffer_load_dwordx4 v[164:167], v255, s[44:47], s37 offen sc1
  buffer_load_dwordx4 v[168:171], v255, s[44:47], s38 offen sc1
  buffer_load_dwordx4 v[112:115], v27, s[44:47], s9 offen sc1
  buffer_load_dwordx4 v[116:119], v27, s[44:47], s10 offen sc1
  buffer_load_dwordx4 v[120:123], v27, s[44:47], s11 offen sc1
  buffer_load_dwordx4 v[124:127], v27, s[44:47], s12 offen sc1
  buffer_load_dwordx4 v[128:131], v27, s[44:47], s13 offen sc1
  buffer_load_dwordx4 v[132:135], v27, s[44:47], s14 offen sc1
  buffer_load_dwordx4 v[136:139], v27, s[44:47], s15 offen sc1
L_ck8:
  s_waitcnt vmcnt(0)
  v_xor_b32 v112, s60, v112
  v_xor_b32 v113, s61, v113
  v_xor_b32 v114, s62, v114
  v_xor_b32 v115, s63, v115
  v_xor_b32 v146, s64, v146
  v_xor_b32 v147, s65, v147
  v_or3_b32 v246, v112, v113, v114
  v_or_b32 v246, v246, v115
  v_or_b32 v247, v146, v147
  v_xor_b32 v116, s60, v116
  v_xor_b32 v117, s61, v117
  v_xor_b32 v118, s62, v118
  v_xor_b32 v119, s63, v119
  v_xor_b32 v150, s64, v150
  v_xor_b32 v151, s65, v151
  v_or3_b32 v246, v246, v116, v117
  v_or3_b32 v246, v246, v118, v119
  v_or3_b32 v247, v247, v150, v151
  v_xor_b32 v120, s60, v120
  v_xor_b32 v121, s61, v121
  v_xor_b32 v122, s62, v122
  v_xor_b32 v123, s63, v123
  v_xor_b32 v154, s64, v154
  v_xor_b32 v155, s65, v155
  v_or3_b32 v246, v246, v120, v121
  v_or3_b32 v246, v246, v122, v123
  v_or3_b32 v247, v247, v154, v155
  v_xor_b32 v124, s60, v124
  v_xor_b32 v125, s61, v125
  v_xor_b32 v126, s62, v126
  v_xor_b32 v127, s63, v127
  v_xor_b32 v158, s64, v158
  v_xor_b32 v159, s65, v159
  v_or3_b32 v246, v246, v124, v125
  v_or3_b32 v246, v246, v126, v127
  v_or3_b32 v247, v247, v158, v159
  v_xor_b32 v128, s60, v128
  v_xor_b32 v129, s61, v129
  v_xor_b32 v130, s62, v130
  v_xor_b32 v131, s63, v131
  v_xor_b32 v162, s64, v162
  v_xor_b32 v163, s65, v163
  v_or3_b32 v246, v246, v128, v129
  v_or3_b32 v246, v246, v130, v131
  v_or3_b32 v247, v247, v162, v163
  v_xor_b32 v132, s60, v132
  v_xor_b32 v133, s61, v133
  v_xor_b32 v134, s62, v134
  v_xor_b32 v135, s63, v135
  v_xor_b32 v166, s64, v166
  v_xor_b32 v167, s65, v167
  v_or3_b32 v246, v246, v132, v133
  v_or3_b32 v246, v246, v134, v135
  v_or3_b32 v247, v247, v166, v167
  v_xor_b32 v136, s60, v136
  v_xor_b32 v137, s61, v137
  v_xor_b32 v138, s62, v138
  v_xor_b32 v139, s63, v139
  v_xor_b32 v170, s64, v170
  v_xor_b32 v171, s65, v171
  v_or3_b32 v246, v246, v136, v137
  v_or3_b32 v246, v246, v138, v139
  v_or3_b32 v247, v247, v170, v171
  v_and_b32 v246, 0xfff, v246
  v_or_b32 v246, v246, v247
  v_cmp_ne_u32 vcc, 0, v246
  s_add_u32 s77, s77, 1
  s_nop 2
  s_cbranch_vccz L_c8
  s_cmp_lt_u32 s77, 0x40000
  s_cbranch_scc1 L_gk8
L_c8:
  v_max_f32 v246, v252, v144
  v_max_f32 v246, v246, v148
  v_max_f32 v246, v246, v152
  v_max_f32 v246, v246, v156
  v_max_f32 v246, v246, v160
  v_max_f32 v246, v246, v164
  v_max_f32 v246, v246, v168
  v_sub_f32 v252, v252, v246
  v_sub_f32 v144, v144, v246
  v_sub_f32 v148, v148, v246
  v_sub_f32 v152, v152, v246
  v_sub_f32 v156, v156, v246
  v_sub_f32 v160, v160, v246
  v_sub_f32 v164, v164, v246
  v_sub_f32 v168, v168, v246
  v_exp_f32 v252, v252
  v_exp_f32 v144, v144
  v_exp_f32 v148, v148
  v_exp_f32 v152, v152
  v_exp_f32 v156, v156
  v_exp_f32 v160, v160
  v_exp_f32 v164, v164
  v_exp_f32 v168, v168
  s_nop 0
  v_mul_f32 v253, v253, v252
  v_fmac_f32 v253, v145, v144
  v_fmac_f32 v253, v149, v148
  v_fmac_f32 v253, v153, v152
  v_fmac_f32 v253, v157, v156
  v_fmac_f32 v253, v161, v160
  v_fmac_f32 v253, v165, v164
  v_fmac_f32 v253, v169, v168
  v_rcp_f32 v253, v253
  v_mul_f32 v248, v248, v252
  v_mul_f32 v249, v249, v252
  v_mul_f32 v250, v250, v252
  v_mul_f32 v251, v251, v252
  v_fmac_f32 v248, v112, v144
  v_fmac_f32 v249, v113, v144
  v_fmac_f32 v250, v114, v144
  v_fmac_f32 v251, v115, v144
  v_fmac_f32 v248, v116, v148
  v_fmac_f32 v249, v117, v148
  v_fmac_f32 v250, v118, v148
  v_fmac_f32 v251, v119, v148
  v_fmac_f32 v248, v120, v152
  v_fmac_f32 v249, v121, v152
  v_fmac_f32 v250, v122, v152
  v_fmac_f32 v251, v123, v152
  v_fmac_f32 v248, v124, v156
  v_fmac_f32 v249, v125, v156
  v_fmac_f32 v250, v126, v156
  v_fmac_f32 v251, v127, v156
  v_fmac_f32 v248, v128, v160
  v_fmac_f32 v249, v129, v160
  v_fmac_f32 v250, v130, v160
  v_fmac_f32 v251, v131, v160
  v_fmac_f32 v248, v132, v164
  v_fmac_f32 v249, v133, v164
  v_fmac_f32 v250, v134, v164
  v_fmac_f32 v251, v135, v164
  v_fmac_f32 v248, v136, v168
  v_fmac_f32 v249, v137, v168
  v_fmac_f32 v250, v138, v168
  v_fmac_f32 v251, v139, v168
L_store1:
  v_mul_f32 v248, v248, v253
  v_mul_f32 v249, v249, v253
  v_mul_f32 v250, v250, v253
  v_mul_f32 v251, v251, v253
  v_cvt_pk_bf16_f32 v248, v248, v249
  v_cvt_pk_bf16_f32 v249, v250, v251
  s_branch L_store2
L_single:
  s_nop 7
  v_rcp_f32 v240, v56
  v_rcp_f32 v241, v60
  s_nop 0
  v_mul_f32 v48, v48, v240
  v_mul_f32 v49, v49, v240
  v_mul_f32 v50, v50, v240
  v_mul_f32 v51, v51, v240
  v_cvt_pk_bf16_f32 v48, v48, v49
  v_cvt_pk_bf16_f32 v49, v50, v51
  v_mul_f32 v52, v52, v241
  v_mul_f32 v53, v53, v241
  v_mul_f32 v54, v54, v241
  v_mul_f32 v55, v55, v241
  v_cvt_pk_bf16_f32 v52, v52, v53
  v_cvt_pk_bf16_f32 v53, v54, v55
  buffer_store_dwordx2 v[48:49], v254, s[40:43], 0 offen
  v_add_u32 v254, 4096, v254
  buffer_store_dwordx2 v[52:53], v254, s[40:43], 0 offen
  s_branch L_fin
L_generic:
  s_waitcnt vmcnt(0)
  s_mov_b32 s19, s69
  s_lshl_b32 s59, s19, 8
  v_and_b32 v248, 7, v0
  v_lshlrev_b32 v248, 2, v248
  s_lshl_b32 s70, s19, 5
  v_add_u32 v249, s70, v248
  global_load_dword v252, v248, s[12:13]
  global_load_dword v253, v249, s[16:17] sc1
  s_lshl_b32 s71, s18, 10
  v_add_u32 v251, s71, v27
  s_add_u32 s71, s71, 131072
  s_mov_b32 m0, s71
  s_mov_b32 s36, s10
  s_and_b32 s37, s11, 0xffff
  s_mov_b32 s38, 4096
  s_mov_b32 s39, 0x20000
  s_cmp_ge_u32 s18, 4
  s_cbranch_scc1 L_notab
  buffer_load_dwordx4 v251, s[36:39], 0 offen lds
L_notab:
  v_lshlrev_b32 v28, 2, v2
  v_add_u32 v28, 17, v28
  v_cvt_f32_u32 v28, v28
  v_add_f32 v29, 1.0, v28
  v_add_f32 v30, 2.0, v28
  v_add_f32 v31, 1.0, v30
  v_rcp_f32 v240, v28
  v_rcp_f32 v241, v29
  v_rcp_f32 v242, v30
  v_rcp_f32 v243, v31
  v_cmp_gt_u32 vcc, 8, v1
  s_nop 0
  v_fma_f32 v244, v240, -0.5, 1.0
  v_fma_f32 v245, v241, -0.5, 1.0
  v_fma_f32 v246, v242, -0.5, 1.0
  v_fma_f32 v247, v243, -0.5, 1.0
  v_cndmask_b32 v250, 0, -1, vcc
  v_mov_b32 v31, 0x800
  v_mov_b32 v64, 0x0da24260
  s_waitcnt vmcnt(0)
  v_cmp_gt_i32 vcc, 1, v252
  v_min_i32 v252, 0x800, v252
  v_mov_b32 v28, 0x3e0293ee
  v_cndmask_b32 v252, v252, v31, vcc
  v_cndmask_b32 v28, v28, v64, vcc
  v_add_u32 v255, 15, v252
  v_lshrrev_b32 v255, 4, v255
  v_and_b32 v255, v255, v250
  v_cvt_f32_u32 v31, v255
  v_fma_f32 v240, v31, v240, v244
  v_fma_f32 v241, v31, v241, v245
  v_fma_f32 v242, v31, v242, v246
  v_fma_f32 v243, v31, v243, v247
  v_cvt_u32_f32 v240, v240
  v_cvt_u32_f32 v241, v241
  v_cvt_u32_f32 v242, v242
  v_cvt_u32_f32 v243, v243
  v_lshl_or_b32 v240, v241, 8, v240
  v_lshl_or_b32 v242, v243, 8, v242
  v_lshl_or_b32 v29, v242, 16, v240
  s_nop 1
  v_add_u32_dpp v30, v29, v29 row_shr:1 row_mask:0xf bank_mask:0xf bound_ctrl:0
  s_nop 1
  v_add_u32_dpp v30, v30, v30 row_shr:2 row_mask:0xf bank_mask:0xf bound_ctrl:0
  s_nop 1
  v_add_u32_dpp v30, v30, v30 row_shr:4 row_mask:0xf bank_mask:0xf bound_ctrl:0
  v_add_u32 v240, 0x5f5f5f5f, v30
  v_and_b32 v240, 0x80808080, v240
  v_bcnt_u32_b32 v240, v240, 0
  s_nop 0
  v_readlane_b32 s70, v240, 7
  v_readlane_b32 s71, v240, 23
  v_readlane_b32 s72, v240, 39
  v_readlane_b32 s73, v240, 55
  s_add_u32 s70, s70, s71
  s_add_u32 s72, s72, s73
  s_add_u32 s70, s70, s72
  s_and_b32 s71, s70, 3
  s_lshl_b32 s71, s71, 3
  s_lshr_b32 s72, s70, 2
  s_lshl_b32 s72, s72, 4
  v_bfe_u32 v30, v30, s71, 8
  v_bfe_u32 v29, v29, s71, 8
  v_cmp_lt_u32 vcc, s20, v30
  s_nop 3
  s_lshr_b64 s[74:75], vcc, s72
  s_and_b32 s74, s74, 0xff
  s_cbranch_scc0 L_end
  s_ff1_i32_b32 s21, s74
  s_add_u32 s72, s72, s21
  v_readlane_b32 s23, v29, s72
  v_readlane_b32 s54, v30, s72
  v_readlane_b32 s48, v255, s72
  v_readlane_b32 s49, v252, s72
  v_readlane_b32 s53, v253, s72
  v_readlane_b32 s52, v28, s72
  s_nop 1
  s_sub_u32 s54, s54, s23
  s_sub_u32 s22, s20, s54
  v_mov_b32 v3, s53
  s_lshl_b32 s70, s21, 9
  s_add_u32 s70, s70, 131072
  v_mul_u32_u24 v28, s23, v0
  v_add_u32 v28, s22, v28
  v_min_u32 v28, 127, v28
  v_lshl_add_u32 v28, v28, 2, s70
  s_barrier
  ds_read_b32 v29, v28
  s_mul_i32 s68, s23, s18
  s_add_u32 s68, s68, s22
  s_add_u32 s73, s18, 8
  s_add_u32 s74, s18, 16
  s_add_u32 s75, s18, 24
  s_waitcnt lgkmcnt(0)
  v_lshl_add_u32 v29, v29, 15, s59
  s_nop 0
  v_readlane_b32 s55, v29, s18
  v_readlane_b32 s56, v29, s73
  v_readlane_b32 s57, v29, s74
  v_readlane_b32 s58, v29, s75
  s_lshl_b32 s76, s21, 16
  s_lshl_b32 s77, s19, 13
  s_add_u32 s76, s76, s77
  s_lshl_b32 s77, s18, 10
  s_add_u32 s77, s77, 135168
  s_mov_b32 m0, s77
  s_nop 3
  s_branch L_common
.section .rodata,"a"
.p2align 6
.amdhsa_kernel standalone__paged_block_table_kv_pagedattention__sampling_kernel
  .amdhsa_next_free_vgpr 256
  .amdhsa_next_free_sgpr 102
  .amdhsa_accum_offset 256
  .amdhsa_group_segment_fixed_size 0
  .amdhsa_kernarg_size 64
  .amdhsa_user_sgpr_count 2
  .amdhsa_user_sgpr_kernarg_segment_ptr 1
  .amdhsa_system_sgpr_workgroup_id_x 1
.end_amdhsa_kernel
```
